```python
import torch

def _softmax(x, axis=-1):
    return torch.softmax(x, dim=axis)
def _gelu(x):
    return torch.nn.functional.gelu(x, approximate="tanh")
def _silu(x):
    return torch.nn.functional.silu(x)
def _sigmoid(x):
    return torch.sigmoid(x)
def _layernorm(x, axis=-1, eps=1e-5):
    m = x.mean(dim=axis, keepdim=True)
    v = x.var(dim=axis, keepdim=True, unbiased=False)
    return (x - m) / torch.sqrt(v + eps)
def _scatter_add(tgt, idx, src, axis=0):
    return tgt.clone().index_add_(axis, idx, src)
def _segment_sum(src, seg, n):
    out = torch.zeros((n,) + src.shape[1:], dtype=src.dtype)
    return out.index_add_(0, seg, src)
def _pad(x, pw):
    flat = tuple(v for pair in reversed(pw) for v in pair)
    return torch.nn.functional.pad(x, flat)

kernel_name = 'standalone__edge_featured_mpnn_mpnn__graph'

def setup_inputs():

    _w = (lambda a: (lambda t: t.to(torch.bfloat16) if t.is_floating_point() else t)(torch.as_tensor(a)))
    N, deg, D, De = 12500, 32, 128, max(4, 1)
    E = N * deg
    H = 2 * D
    return {
        "x": _w((lambda *s: torch.randn(*s, dtype=torch.bfloat16) * 0.05)(N, D)),
        "e_attr": _w((lambda *s: torch.randn(*s, dtype=torch.bfloat16) * 1.6)(E, De)),
        "src": _w((lambda lo, hi, *s: torch.randint(lo, hi, s))(0, N, E).to(torch.int64)),
        "dst": _w((lambda lo, hi, *s: torch.randint(lo, hi, s))(0, N, E).to(torch.int64)),
        "w1": _w((lambda *s: torch.randn(*s, dtype=torch.bfloat16) * 1.6)(2 * D + De, H) * (1.0 / (2 * D + De) ** 0.5)),
        "b1": _w((lambda *s: torch.randn(*s, dtype=torch.bfloat16) * 3.2)(H) * 0.01),
        "w2": _w((lambda *s: torch.randn(*s, dtype=torch.bfloat16) * 0.05)(H, D) * (1.0 / H ** 0.5)),
        "b2": _w((lambda *s: torch.randn(*s, dtype=torch.bfloat16) * 0.1)(D) * 0.01),
    }

def reference(x, e_attr, src, dst, w1, b1, w2, b2):
    N, D = x.shape
    h_src = x[src]
    h_dst = x[dst]
    m_in = torch.concatenate([h_src, h_dst, e_attr], axis=-1)
    h = _silu(m_in @ w1 + b1)
    msg = h @ w2 + b2
    return _segment_sum(msg, dst, N)
```

```asm
; @launch grid=(256,1,1) block=(512,1,1) lds=160800
.amdgcn_target "amdgcn-amd-amdhsa--gfx950"
.text
.globl standalone__edge_featured_mpnn_mpnn__graph_kernel
.p2align 8
.type standalone__edge_featured_mpnn_mpnn__graph_kernel,@function
standalone__edge_featured_mpnn_mpnn__graph_kernel:
    s_load_dwordx16 s[4:19], s[0:1], 0
    s_load_dwordx4 s[20:23], s[0:1], 64
    s_load_dwordx2 s[58:59], s[0:1], 80
    s_cmp_ge_u32 s2, 256
    s_cbranch_scc1 K_END
    s_getpc_b64 s[60:61]
K_PC:
    s_and_b32 s61, s61, 0xffff
    s_mov_b32 s62, K_END-K_PC
    s_mov_b32 s63, 0x20000
    v_lshlrev_b32 v2, 7, v0
    buffer_load_dword v4, v2, s[60:63], 0 offen
    s_mul_i32 s84, s2, 6400
    v_lshlrev_b32 v2, 4, v0
    s_cmp_lt_u32 s2, 250
    s_cselect_b32 s54, 6400, 0
    s_cselect_b32 s84, s84, 0
    s_mov_b32 s55, s63
    s_waitcnt lgkmcnt(0)
    s_add_u32 s52, s10, s84
    s_addc_u32 s53, s11, 0
    s_and_b32 s53, s53, 0xffff
    buffer_load_dwordx4 v[4:7], v2, s[52:55], 0 offen sc0 sc1 nt
    v_and_b32 v1, 63, v0
    v_lshrrev_b32 v68, 6, v0
    v_lshlrev_b32 v3, 5, v0
    s_mov_b32 s66, s54
    s_lshl_b32 s70, s54, 1
    v_readfirstlane_b32 s24, v68
    s_lshr_b32 s46, s54, 4
    s_lshl_b32 s85, s84, 1
    s_mov_b32 s67, s63
    s_mov_b32 s71, s63
    s_and_b32 s86, s2, 7
    s_lshl_b32 s86, s86, 5
    s_lshr_b32 s3, s2, 3
    s_or_b32 s3, s3, s86
    v_and_b32 v71, 255, v0
    v_lshlrev_b32 v71, 2, v71
    v_mov_b32 v72, 0
    ds_write_b32 v71, v72 offset:14880
    ds_write_b32 v72, v72 offset:13104
    ds_write_b32 v72, v72 offset:13112
    ds_write_b32 v72, v72 offset:13120
    s_add_u32 s64, s8, s84
    s_addc_u32 s65, s9, 0
    s_and_b32 s65, s65, 0xffff
    s_add_u32 s68, s6, s85
    s_addc_u32 s69, s7, 0
    s_and_b32 s69, s69, 0xffff
    s_mov_b32 s60, s12
    s_and_b32 s61, s13, 0xffff
    s_mov_b32 s62, 133120
    s_mov_b32 s63, 0x20000
    s_mov_b64 s[56:57], s[22:23]
    s_add_u32 s22, s58, 0
    s_addc_u32 s23, s59, 0
    s_and_b32 s26, s24, 3
    s_mul_i32 s27, s3, 399997
    s_add_u32 s28, s27, 408188
    s_add_u32 s27, s27, 8191
    s_lshr_b32 s27, s27, 13
    s_lshr_b32 s28, s28, 13
    s_sub_u32 s28, s28, s27
    s_cmp_eq_u32 s24, 7
    s_cbranch_scc0 K_E7X
    s_cmp_lg_u32 s2, 0
    s_cbranch_scc1 K_NONP
    s_mov_b32 s36, s56
    s_and_b32 s37, s57, 0xffff
    s_mov_b32 s38, 256
    s_mov_b32 s39, 0x20000
    s_memrealtime s[86:87]
    s_waitcnt lgkmcnt(0)
    s_and_b32 s87, s87, 0x3fff
    s_bitset1_b32 s87, 31
    v_mov_b32 v68, s86
    v_mov_b32 v69, s87
    s_mov_b64 exec, 1
    buffer_store_dwordx2 v[68:69], off, s[36:39], 0 sc1
    s_mov_b64 exec, -1
K_NONP:
    v_lshlrev_b32 v70, 4, v1
    s_mov_b32 s86, 64032
    s_mov_b32 m0, s86
    s_mov_b32 s87, 131072
    buffer_load_dwordx4 v70, s[60:63], s87 offen lds
    buffer_load_dwordx4 v70, s[60:63], s87 offen offset:1024 lds
    s_mov_b32 s36, s14
    s_and_b32 s37, s15, 0xffff
    s_mov_b32 s38, 512
    s_mov_b32 s39, 0x20000
    s_add_u32 m0, s86, 2048
    s_nop 0
    buffer_load_dwordx4 v70, s[36:39], 0 offen lds
    s_mov_b32 s36, s18
    s_and_b32 s37, s19, 0xffff
    s_mov_b32 s38, 256
    s_mov_b32 s39, 0x20000
    s_movk_i32 s86, 13840
    s_mov_b32 m0, s86
    s_mov_b64 exec, 0xffff
    buffer_load_dwordx4 v70, s[36:39], 0 offen lds
    s_mov_b64 exec, -1
    s_lshr_b32 s88, s2, 3
    s_and_b32 s88, s88, 3
    s_lshl_b32 s88, s88, 14
    s_add_u32 s88, s88, 65536
    v_lshlrev_b32 v71, 7, v1
    s_add_u32 s89, s88, 8192
    buffer_load_dword v97, v71, s[60:63], s88 offen
    buffer_load_dword v98, v71, s[60:63], s89 offen
    s_branch K_E7C
K_E7X:
    buffer_load_dwordx4 v[8:11], v2, s[64:67], 0 offen sc0 sc1 nt
    buffer_load_dwordx4 v[12:15], v3, s[68:71], 0 offen sc0 sc1 nt
    buffer_load_dwordx4 v[16:19], v3, s[68:71], 0 offen offset:16 sc0 sc1 nt
K_E7C:
    s_lshr_b32 s25, s24, 2
    s_sub_u32 s88, s2, 250
    s_cmp_lt_u32 s88, 4
    s_cbranch_scc1 K_W2A_O
K_W2A:
    s_waitcnt lgkmcnt(0)
    s_barrier
    s_mov_b32 s32, s22
    s_and_b32 s33, s23, 0xffff
    s_mov_b32 s34, 268435456
    s_mov_b32 s35, 0x20000
    v_lshrrev_b32 v68, 5, v1
    v_and_b32 v149, 31, v1
    v_lshlrev_b32 v69, 2, v68
    v_xor_b32 v149, v149, v69
    v_lshlrev_b32 v149, 4, v149
    v_lshl_add_u32 v149, v68, 9, v149
    v_xor_b32 v151, 0x80, v149
    s_mov_b32 s47, 21475
    s_mov_b32 s30, 399997
    v_mov_b32 v104, 8191
    v_mov_b32 v105, 1
    v_cmp_gt_u32 s[72:73], s46, v0
    s_mov_b32 s29, 0
    s_mov_b32 s31, 0
    s_mov_b32 s40, 1.0
    s_mov_b32 s41, 1.0
    s_mul_i32 s44, s24, 8320
    s_add_u32 s44, s44, 94240
    s_add_u32 s45, s44, 4160
    s_lshl_b32 s86, s26, 7
    s_add_u32 s48, s22, s86
    s_addc_u32 s49, s23, 0
    s_and_b32 s49, s49, 0xffff
    s_or_b32 s49, s49, 0x100000
    s_mov_b32 s50, -1
    s_mov_b32 s51, 0x800000
    v_lshrrev_b32 v72, 5, v1
    v_bfe_u32 v68, v1, 2, 2
    v_lshl_add_u32 v69, v72, 3, v68
    v_bfe_u32 v70, v1, 4, 1
    v_bfe_u32 v71, v1, 1, 1
    v_lshl_add_u32 v70, v70, 1, v71
    s_lshl_b32 s86, s24, 2
    v_add_u32 v70, s86, v70
    v_lshlrev_b32 v68, 2, v68
    v_xor_b32 v70, v70, v68
    v_lshlrev_b32 v70, 4, v70
    v_lshl_add_u32 v70, v69, 9, v70
    v_and_b32 v68, 1, v1
    v_lshl_add_u32 v70, v68, 3, v70
    v_add_u32 v155, 94240, v70
    v_and_b32 v68, 31, v1
    v_lshlrev_b32 v69, 8, v68
    v_add_u32 v69, 36384, v69
    v_and_b32 v70, 15, v1
    v_xor_b32 v70, v72, v70
    v_lshlrev_b32 v70, 4, v70
    v_xad_u32 v112, v70, 0, v69
    v_xad_u32 v113, v70, 32, v69
    v_xad_u32 v114, v70, 64, v69
    s_movk_i32 s86, 96
    v_xad_u32 v115, v70, s86, v69
    s_movk_i32 s86, 128
    v_xad_u32 v116, v70, s86, v69
    s_movk_i32 s86, 160
    v_xad_u32 v117, v70, s86, v69
    s_movk_i32 s86, 192
    v_xad_u32 v118, v70, s86, v69
    s_movk_i32 s86, 224
    v_xad_u32 v119, v70, s86, v69
    v_mul_u32_u24 v68, 528, v68
    v_lshl_add_u32 v68, v72, 3, v68
    s_lshl_b32 s86, s24, 6
    s_add_u32 s86, s86, 68128
    v_add_u32 v111, s86, v68
    v_lshrrev_b32 v68, 5, v0
    v_and_b32 v69, 31, v0
    v_lshlrev_b32 v69, 4, v69
    v_mad_u32_u24 v109, v68, 16, v69
    v_lshl_add_u32 v110, v68, 9, v69
    v_lshl_add_u32 v109, v68, 9, v109
    v_add_u32 v109, 68128, v109
    v_mov_b32 v158, 0
    v_mov_b32 v74, 0x3f80
    v_lshrrev_b32 v68, 5, v1
    v_bfe_u32 v69, v1, 3, 1
    v_lshl_or_b32 v68, v68, 2, v69
    v_bfe_u32 v69, v1, 4, 1
    v_lshl_or_b32 v68, v68, 2, v69
    v_and_b32 v69, 3, v1
    v_lshl_or_b32 v68, v68, 2, v69
    v_and_b32 v69, 4, v1
    v_cmp_ne_u32 vcc, 0, v69
    v_lshl_add_u32 v68, v68, 3, s44
    s_add_u32 s86, s44, 1024
    v_mov_b32 v69, s86
    v_add_u32 v70, 0, v68
    v_cndmask_b32 v136, v69, v70, vcc
    v_add_u32 v70, 64, v68
    v_cndmask_b32 v137, v69, v70, vcc
    v_add_u32 v70, 256, v68
    v_cndmask_b32 v138, v69, v70, vcc
    v_add_u32 v70, 320, v68
    v_cndmask_b32 v139, v69, v70, vcc
    v_bfe_u32 v69, v1, 3, 2
    v_mul_u32_u24 v69, 5, v69
    v_bfe_u32 v69, v69, 1, 2
    v_lshrrev_b32 v70, 3, v1
    v_and_or_b32 v69, v70, 4, v69
    v_lshlrev_b32 v148, 4, v69
    v_bfe_u32 v68, v1, 4, 1
    v_and_b32 v69, 1, v1
    v_lshl_or_b32 v68, v69, 1, v68
    v_bfe_u32 v69, v1, 2, 1
    v_lshl_or_b32 v68, v69, 2, v68
    v_bfe_u32 v70, v1, 1, 1
    v_bfe_u32 v71, v1, 3, 1
    v_lshl_or_b32 v70, v71, 1, v70
    v_lshrrev_b32 v72, 5, v1
    v_lshl_add_u32 v3, v68, 2, v70
    v_lshlrev_b32 v3, 4, v3
    v_cmp_eq_u32 s[42:43], v69, v72
    v_mov_b32 v73, 1024
    s_mul_i32 s86, s26, 9600
    v_cndmask_b32 v150, 0, v73, s[42:43]
    v_bfe_u32 v68, v1, 4, 1
    v_and_b32 v69, 3, v1
    v_lshlrev_b32 v69, 3, v69
    v_lshl_add_u32 v68, v68, 5, v69
    s_add_u32 s86, s86, 55840
    v_add_u32 v156, s86, v68
    v_bfe_u32 v68, v1, 3, 1
    v_bfe_u32 v69, v1, 2, 1
    v_lshl_or_b32 v68, v69, 1, v68
    v_lshl_or_b32 v68, v72, 2, v68
    v_lshlrev_b32 v159, 2, v68
    v_mov_b32 v36, 0
    v_mov_b32 v37, 0
    v_mov_b32 v38, 0
    v_mov_b32 v39, 0
    v_lshlrev_b32 v69, 2, v1
    ds_write_b32 v69, v36 offset:12816
    v_bfe_u32 v69, v0, 0, 2
    v_mul_u32_u24 v69, 5, v69
    v_bfe_u32 v69, v69, 1, 2
    v_and_or_b32 v69, v0, 4, v69
    v_lshlrev_b32 v69, 7, v69
    v_sub_u32 v40, 6404096, v69
    v_subrev_u32 v41, 1040, v40
    v_subrev_u32 v42, 2080, v40
    v_subrev_u32 v43, 3120, v40
    ds_write_b128 v2, v[40:43] offset:2560
    v_and_b32 v69, 127, v0
    v_lshlrev_b32 v70, 4, v69
    ds_write_b128 v70, v[40:43] offset:10752
    v_mov_b32 v71, 9408
    v_lshlrev_b32 v70, 2, v0
    ds_write_b32 v70, v71 offset:0
    v_lshlrev_b32 v69, 2, v69
    ds_write_b32 v69, v71 offset:2048
    s_mov_b32 s36, s4
    s_and_b32 s37, s5, 0xffff
    s_mov_b32 s38, 3200000
    s_mov_b32 s39, 0x20000
    v_lshrrev_b32 v80, 4, v1
    s_and_b32 s86, s24, 1
    s_lshl_b32 s86, s86, 3
    v_add_u32 v81, s86, v80
    v_and_b32 v82, 15, v1
    v_xor_b32 v81, v81, v82
    v_lshlrev_b32 v81, 4, v81
    v_lshl_add_u32 v81, v80, 8, v81
    v_xor_b32 v80, 64, v81
    s_cmp_eq_u32 s24, 7
    s_cbranch_scc1 K_H7
    s_waitcnt vmcnt(3)
K_H7:
    s_mov_b64 exec, s[72:73]
    v_mul_u32_u24 v28, s47, v4
    v_mul_u32_u24 v29, s47, v5
    v_mul_u32_u24 v30, s47, v6
    v_mul_u32_u24 v31, s47, v7
    v_lshrrev_b32 v28, 20, v28
    v_lshrrev_b32 v29, 20, v29
    v_lshrrev_b32 v30, 20, v30
    v_lshrrev_b32 v31, 20, v31
    v_lshlrev_b32 v20, 2, v28
    v_lshlrev_b32 v21, 2, v29
    v_lshlrev_b32 v22, 2, v30
    v_lshlrev_b32 v23, 2, v31
    ds_add_rtn_u32 v24, v20, v105 offset:14880
    ds_add_rtn_u32 v25, v21, v105 offset:14880
    ds_add_rtn_u32 v26, v22, v105 offset:14880
    ds_add_rtn_u32 v27, v23, v105 offset:14880
    v_mad_u32_u24 v28, v28, s30, v104
    v_mad_u32_u24 v29, v29, s30, v104
    v_mad_u32_u24 v30, v30, s30, v104
    v_mad_u32_u24 v31, v31, s30, v104
    v_lshrrev_b32 v28, 13, v28
    v_lshrrev_b32 v29, 13, v29
    v_lshrrev_b32 v30, 13, v30
    v_lshrrev_b32 v31, 13, v31
    v_sub_u32 v28, v4, v28
    v_sub_u32 v29, v5, v29
    v_sub_u32 v30, v6, v30
    v_sub_u32 v31, v7, v31
    s_mov_b64 exec, -1
    s_lshl_b32 s86, s24, 11
    s_lshl_b32 s87, s27, 8
    s_add_u32 s87, s87, s86
    s_add_u32 m0, s86, 36384
    s_lshr_b32 s25, s24, 2
    buffer_load_dwordx4 v81, s[36:39], s87 offen nt lds
    buffer_load_dwordx4 v80, s[36:39], s87 offen offset:1024 nt lds
    s_lshl_b32 s84, s24, 11
    s_add_u32 m0, s84, 94240
    v_lshlrev_b32 v104, 4, v1
    buffer_load_dwordx4 v149, s[60:63], s84 offen lds
    buffer_load_dwordx4 v151, s[60:63], s84 offen offset:1024 lds
    s_waitcnt lgkmcnt(0)
    s_barrier
    s_mov_b32 s36, s56
    s_and_b32 s37, s57, 0xffff
    s_mov_b32 s38, 256
    s_mov_b32 s39, 0x20000
    ds_read_b128 v[4:7], v104 offset:14880
    s_waitcnt lgkmcnt(0)
    v_add_u32 v68, v4, v5
    v_add_u32 v69, v68, v6
    v_add_u32 v70, v69, v7
    v_mov_b32 v71, v70
    s_nop 1
    v_add_u32_dpp v71, v71, v71 row_shr:1 row_mask:0xf bank_mask:0xf bound_ctrl:0
    s_nop 1
    v_add_u32_dpp v71, v71, v71 row_shr:2 row_mask:0xf bank_mask:0xf bound_ctrl:0
    s_nop 1
    v_add_u32_dpp v71, v71, v71 row_shr:4 row_mask:0xf bank_mask:0xf bound_ctrl:0
    s_nop 1
    v_add_u32_dpp v71, v71, v71 row_shr:8 row_mask:0xf bank_mask:0xf bound_ctrl:0
    s_nop 1
    v_add_u32_dpp v71, v71, v71 row_bcast:15 row_mask:0xa bank_mask:0xf
    s_nop 1
    v_add_u32_dpp v71, v71, v71 row_bcast:31 row_mask:0xc bank_mask:0xf
    v_sub_u32 v32, v71, v70
    v_add_u32 v33, v32, v4
    v_add_u32 v34, v32, v68
    v_add_u32 v35, v32, v69
    v_lshl_or_b32 v120, v4, 11, v32
    v_lshl_or_b32 v121, v5, 11, v33
    v_lshl_or_b32 v122, v6, 11, v34
    v_lshl_or_b32 v123, v7, 11, v35
    s_cmp_lg_u32 s24, 7
    s_cbranch_scc1 K_NON1X
    buffer_load_dwordx2 v[92:93], off, s[36:39], 0 sc1
    s_movk_i32 s84, 0x4000
K_W7L:
    s_add_u32 m0, s84, 94240
    s_nop 0
    buffer_load_dwordx4 v149, s[60:63], s84 offen offset:0 lds
    buffer_load_dwordx4 v151, s[60:63], s84 offen offset:1024 lds
    buffer_load_dwordx4 v149, s[60:63], s84 offen offset:2048 lds
    buffer_load_dwordx4 v151, s[60:63], s84 offen offset:3072 lds
    s_add_u32 s84, s84, 4096
    s_cmp_lt_u32 s84, 0x10000
    s_cbranch_scc1 K_W7L
    s_waitcnt vmcnt(55)
    s_branch K_W7D
K_NON1X:
    ds_write_b128 v104, v[32:35] offset:15904
    s_mov_b64 exec, s[72:73]
    s_waitcnt lgkmcnt(0)
    ds_read_b32 v4, v20 offset:15904
    ds_read_b32 v5, v21 offset:15904
    ds_read_b32 v6, v22 offset:15904
    ds_read_b32 v7, v23 offset:15904
    s_waitcnt vmcnt(4)
    v_lshl_or_b32 v28, v28, 16, v8
    v_lshl_or_b32 v29, v29, 16, v9
    v_lshl_or_b32 v30, v30, 16, v10
    v_lshl_or_b32 v31, v31, 16, v11
    v_mov_b32 v68, 16928
    s_waitcnt lgkmcnt(0)
    v_add_u32 v4, v4, v24
    v_add_u32 v5, v5, v25
    v_add_u32 v6, v6, v26
    v_add_u32 v7, v7, v27
    v_mad_u32_u24 v4, v4, 12, v68
    v_mad_u32_u24 v5, v5, 12, v68
    v_mad_u32_u24 v6, v6, 12, v68
    v_mad_u32_u24 v7, v7, 12, v68
    ds_write2_b32 v4, v12, v13 offset0:0 offset1:1
    ds_write_b32 v4, v28 offset:8
    ds_write2_b32 v5, v14, v15 offset0:0 offset1:1
    ds_write_b32 v5, v29 offset:8
    ds_write2_b32 v6, v16, v17 offset0:0 offset1:1
    ds_write_b32 v6, v30 offset:8
    ds_write2_b32 v7, v18, v19 offset0:0 offset1:1
    ds_write_b32 v7, v31 offset:8
    s_mov_b64 exec, -1
K_W7D:
    s_mul_i32 s84, s2, 19200
    s_add_u32 s84, s84, 8388608
    s_add_u32 s52, s22, s84
    s_addc_u32 s53, s23, 0
    s_and_b32 s53, s53, 0xffff
    s_mul_i32 s54, s46, 48
    s_lshl_b32 s84, s27, 9
    s_add_u32 s84, s84, 4096
    s_add_u32 s64, s22, s84
    s_addc_u32 s65, s23, 0
    s_and_b32 s65, s65, 0xffff
    s_lshl_b32 s66, s28, 9
    s_waitcnt lgkmcnt(0)
    s_barrier
    ds_read_b128 v[4:7], v2 offset:16928
    ds_read_b128 v[8:11], v2 offset:25120
    ds_read_b128 v[12:15], v2 offset:33312
    s_movk_i32 s84, 0x2000
    s_movk_i32 s85, 0x4000
    s_waitcnt lgkmcnt(2)
    buffer_store_dwordx4 v[4:7], v2, s[52:55], 0 offen sc1
    s_waitcnt lgkmcnt(1)
    buffer_store_dwordx4 v[8:11], v2, s[52:55], s84 offen sc1
    s_waitcnt lgkmcnt(0)
    buffer_store_dwordx4 v[12:15], v2, s[52:55], s85 offen sc1
    v_and_b32 v68, 31, v1
    v_lshlrev_b32 v68, 1, v68
    s_lshl_b32 s86, s26, 7
    s_add_u32 s86, s86, 64032
    v_add_u32 v69, s86, v68
    s_lshl_b32 s86, s24, 6
    s_add_u32 s86, s86, 64032
    v_add_u32 v70, s86, v68
    ds_read_u16 v124, v69 offset:0
    ds_read_u16 v125, v69 offset:512
    ds_read_u16 v126, v69 offset:1024
    ds_read_u16 v127, v69 offset:1536
    ds_read_u16 v128, v69 offset:64
    ds_read_u16 v129, v69 offset:576
    ds_read_u16 v130, v69 offset:1088
    ds_read_u16 v131, v69 offset:1600
    ds_read_u16 v132, v70 offset:2048
    s_waitcnt lgkmcnt(0)
    v_mov_b32 v96, 0
    s_cmp_eq_u32 s24, 7
    s_cbranch_scc1 K_B3W
    s_waitcnt vmcnt(3)
K_B3W:
    s_waitcnt vmcnt(35)
    s_barrier
    s_sub_u32 s88, s2, 250
    s_cmp_lt_u32 s88, 4
    s_cbranch_scc1 K_W2R_O
K_W2R:
    ds_read_b64_tr_b16 v[160:161], v155 offset:0
    ds_read_b64_tr_b16 v[162:163], v155 offset:2048
    ds_read_b128 v[192:195], v112 offset:0
    ds_read_b128 v[224:227], v112 offset:8192
    ds_read_b64_tr_b16 v[164:165], v155 offset:8192
    ds_read_b64_tr_b16 v[166:167], v155 offset:10240
    ds_read_b128 v[196:199], v113 offset:0
    ds_read_b128 v[228:231], v113 offset:8192
    ds_read_b64_tr_b16 v[168:169], v155 offset:16384
    ds_read_b64_tr_b16 v[170:171], v155 offset:18432
    ds_read_b128 v[200:203], v114 offset:0
    ds_read_b128 v[232:235], v114 offset:8192
    s_waitcnt lgkmcnt(8)
    v_mfma_f32_32x32x16_bf16 v[36:51], v[160:163], v[192:195], 0
    v_lshrrev_b32 v68, 1, v1
    v_min_u32 v68, 24, v68
    s_mul_i32 s86, s25, 25
    v_mfma_f32_32x32x16_bf16 v[52:67], v[160:163], v[224:227], 0
    v_add_u32 v69, s86, v68
    v_mul_u32_u24 v69, 192, v69
    s_mul_i32 s86, s26, 9600
    ds_read_b64_tr_b16 v[172:173], v155 offset:24576
    ds_read_b64_tr_b16 v[174:175], v155 offset:26624
    ds_read_b128 v[204:207], v115 offset:0
    ds_read_b128 v[236:239], v115 offset:8192
    s_waitcnt lgkmcnt(8)
    v_mfma_f32_32x32x16_bf16 v[36:51], v[164:167], v[196:199], v[36:51]
    v_add_u32 v69, s86, v69
    v_and_b32 v70, 1, v1
    v_lshl_add_u32 v100, v70, 5, v69
    v_mfma_f32_32x32x16_bf16 v[52:67], v[164:167], v[228:231], v[52:67]
    v_lshl_add_u32 v101, v68, 1, v69
    v_lshrrev_b32 v71, 4, v1
    v_mul_u32_u24 v71, 9600, v71
    ds_read_b128 v[208:211], v116 offset:0
    ds_read_b128 v[240:243], v116 offset:8192
    ds_read_b128 v[212:215], v117 offset:0
    ds_read_b128 v[244:247], v117 offset:8192
    s_waitcnt lgkmcnt(8)
    v_mfma_f32_32x32x16_bf16 v[36:51], v[168:171], v[200:203], v[36:51]
    v_and_b32 v72, 15, v1
    v_min_u32 v72, 11, v72
    v_lshl_add_u32 v102, v72, 4, v71
    v_mfma_f32_32x32x16_bf16 v[52:67], v[168:171], v[232:235], v[52:67]
    v_lshrrev_b32 v69, 5, v1
    s_lshr_b32 s88, s24, 1
    s_mul_i32 s88, s88, 9600
    ds_read_b128 v[216:219], v118 offset:0
    ds_read_b128 v[248:251], v118 offset:8192
    ds_read_b128 v[220:223], v119 offset:0
    ds_read_b128 v[252:255], v119 offset:8192
    s_waitcnt lgkmcnt(8)
    s_waitcnt vmcnt(0)
    v_mov_b32 v73, 0
    s_cmp_lg_u32 s24, 7
    s_cbranch_scc1 K_NON3
    s_movk_i32 s91, 30000
K_NON2:
    v_cmp_gt_i32 vcc, 0, v93
    s_sub_u32 s91, s91, 1
    s_cmp_eq_u32 s91, 0
    s_cbranch_scc1 K_NON4
    s_cbranch_vccnz K_NON4
    s_sleep 2
    buffer_load_dwordx2 v[92:93], off, s[36:39], 0 sc1
    s_waitcnt vmcnt(0)
    s_branch K_NON2
K_NON4:
    ds_write_b64 v73, v[92:93] offset:13088
    v_lshlrev_b32 v23, 22, v93
    v_mov_b32 v24, v92
    v_or_b32 v25, v23, v120
    v_mov_b32 v26, v92
    v_or_b32 v27, v23, v121
    v_mov_b32 v28, v92
    v_or_b32 v29, v23, v122
    v_mov_b32 v30, v92
    v_or_b32 v31, v23, v123
    v_readfirstlane_b32 s90, v92
    s_mul_i32 s90, s90, 0x9e3779b1
    s_mul_hi_u32 s90, s90, 16
    s_add_u32 s90, s90, 2
    s_lshl_b32 s90, s90, 23
    s_add_u32 s90, s90, 7340032
    s_lshl_b32 s91, s2, 11
    s_add_u32 s91, s91, s90
    s_waitcnt lgkmcnt(0)
K_NON3:
    v_lshlrev_b32 v22, 5, v1
    s_barrier
    s_cmp_lg_u32 s24, 7
    s_cbranch_scc1 K_PUBD
    buffer_store_dwordx4 v[24:27], v22, s[32:35], s91 offen sc1
    buffer_store_dwordx4 v[28:31], v22, s[32:35], s91 offen offset:16 sc1
K_PUBD:
    ds_read_b64_tr_b16 v[176:177], v155 offset:32768
    ds_read_b64_tr_b16 v[178:179], v155 offset:34816
    ds_read_b64_tr_b16 v[180:181], v155 offset:40960
    ds_read_b64_tr_b16 v[182:183], v155 offset:43008
    v_mfma_f32_32x32x16_bf16 v[36:51], v[172:175], v[204:207], v[36:51]
    s_and_b32 s89, s24, 1
    s_lshl_b32 s89, s89, 6
    s_add_u32 s88, s88, s89
    v_mfma_f32_32x32x16_bf16 v[52:67], v[172:175], v[236:239], v[52:67]
    s_add_u32 s88, s88, 55840
    v_and_b32 v70, 31, v1
    v_mul_u32_u24 v69, 768, v69
    ds_read_b64_tr_b16 v[184:185], v155 offset:49152
    ds_read_b64_tr_b16 v[186:187], v155 offset:51200
    s_waitcnt lgkmcnt(4)
    v_mfma_f32_32x32x16_bf16 v[36:51], v[176:179], v[208:211], v[36:51]
    v_lshl_add_u32 v69, v70, 1, v69
    v_add_u32 v154, s88, v69
    v_lshrrev_b32 v68, 1, v0
    v_mfma_f32_32x32x16_bf16 v[52:67], v[176:179], v[240:243], v[52:67]
    v_mul_u32_u24 v68, 2048, v68
    s_lshl_b32 s84, s3, 3
    v_add_u32 v152, s84, v68
    ds_read_b64_tr_b16 v[188:189], v155 offset:57344
    ds_read_b64_tr_b16 v[190:191], v155 offset:59392
    s_waitcnt lgkmcnt(4)
    v_mfma_f32_32x32x16_bf16 v[36:51], v[180:183], v[212:215], v[36:51]
    v_bfe_u32 v68, v1, 2, 2
    v_lshrrev_b32 v69, 5, v1
    v_lshl_add_u32 v68, v69, 3, v68
    v_mfma_f32_32x32x16_bf16 v[52:67], v[180:183], v[244:247], v[52:67]
    v_bfe_u32 v70, v1, 4, 1
    v_lshl_add_u32 v68, v68, 1, v70
    v_and_b32 v70, 3, v1
    s_waitcnt lgkmcnt(2)
    v_mfma_f32_32x32x16_bf16 v[36:51], v[184:187], v[216:219], v[36:51]
    v_lshlrev_b32 v70, 3, v70
    v_lshl_add_u32 v68, v68, 5, v70
    v_add_u32 v103, s44, v68
    v_mfma_f32_32x32x16_bf16 v[52:67], v[184:187], v[248:251], v[52:67]
    v_lshrrev_b32 v78, 2, v1
    v_and_b32 v79, 3, v1
    v_lshlrev_b32 v79, 4, v79
    s_waitcnt lgkmcnt(0)
    v_mfma_f32_32x32x16_bf16 v[36:51], v[188:191], v[220:223], v[36:51]
    v_lshl_add_u32 v144, v78, 9, v79
    v_mfma_f32_32x32x16_bf16 v[52:67], v[188:191], v[252:255], v[52:67]
    ds_read_b64 v[20:21], v73 offset:13088
    s_waitcnt lgkmcnt(0)
    v_readfirstlane_b32 s58, v20
    v_readfirstlane_b32 s59, v21
    s_lshl_b32 s59, s59, 22
    s_mul_i32 s47, s58, 0x9e3779b1
    s_mul_hi_u32 s47, s47, 16
    s_add_u32 s47, s47, 2
    s_lshl_b32 s47, s47, 23
    s_add_u32 s82, s47, 7340032
    s_add_u32 s83, s47, 7864320
    s_add_u32 s64, s64, s47
    s_addc_u32 s65, s65, 0
    s_add_u32 s48, s48, s47
    s_addc_u32 s49, s49, 0
    s_mov_b32 s86, 0xbfb8aa3b
    s_mov_b32 s87, 0xbfb8aa3b
    v_mov_b32 v153, 0
    s_mov_b32 s88, 0x1ffff
    s_mov_b32 s89, 0x1ffff
    v_pk_mul_f32 v[36:37], v[36:37], s[86:87]
    v_pk_mul_f32 v[38:39], v[38:39], s[86:87]
    v_cvt_pk_bf16_f32 v74, v36, v37
    v_cvt_pk_bf16_f32 v75, v38, v39
    v_max3_f32 v153, |v36|, |v37|, v153
    v_max3_f32 v153, |v38|, |v39|, v153
    ds_write_b64 v111, v[74:75] offset:0
    v_pk_mul_f32 v[40:41], v[40:41], s[86:87]
    v_pk_mul_f32 v[42:43], v[42:43], s[86:87]
    v_cvt_pk_bf16_f32 v76, v40, v41
    v_cvt_pk_bf16_f32 v77, v42, v43
    v_max3_f32 v153, |v40|, |v41|, v153
    v_max3_f32 v153, |v42|, |v43|, v153
    ds_write_b64 v111, v[76:77] offset:16
    v_pk_mul_f32 v[44:45], v[44:45], s[86:87]
    v_pk_mul_f32 v[46:47], v[46:47], s[86:87]
    v_cvt_pk_bf16_f32 v74, v44, v45
    v_cvt_pk_bf16_f32 v75, v46, v47
    v_max3_f32 v153, |v44|, |v45|, v153
    v_max3_f32 v153, |v46|, |v47|, v153
    ds_write_b64 v111, v[74:75] offset:32
    v_pk_mul_f32 v[48:49], v[48:49], s[86:87]
    v_pk_mul_f32 v[50:51], v[50:51], s[86:87]
    v_cvt_pk_bf16_f32 v76, v48, v49
    v_cvt_pk_bf16_f32 v77, v50, v51
    v_max3_f32 v153, |v48|, |v49|, v153
    v_max3_f32 v153, |v50|, |v51|, v153
    ds_write_b64 v111, v[76:77] offset:48
    s_mov_b64 exec, s[88:89]
    v_pk_mul_f32 v[52:53], v[52:53], s[86:87]
    v_pk_mul_f32 v[54:55], v[54:55], s[86:87]
    v_cvt_pk_bf16_f32 v74, v52, v53
    v_cvt_pk_bf16_f32 v75, v54, v55
    v_max3_f32 v153, |v52|, |v53|, v153
    v_max3_f32 v153, |v54|, |v55|, v153
    ds_write_b64 v111, v[74:75] offset:16896
    v_pk_mul_f32 v[56:57], v[56:57], s[86:87]
    v_pk_mul_f32 v[58:59], v[58:59], s[86:87]
    v_cvt_pk_bf16_f32 v76, v56, v57
    v_cvt_pk_bf16_f32 v77, v58, v59
    v_max3_f32 v153, |v56|, |v57|, v153
    v_max3_f32 v153, |v58|, |v59|, v153
    ds_write_b64 v111, v[76:77] offset:16912
    v_pk_mul_f32 v[60:61], v[60:61], s[86:87]
    v_pk_mul_f32 v[62:63], v[62:63], s[86:87]
    v_cvt_pk_bf16_f32 v74, v60, v61
    v_cvt_pk_bf16_f32 v75, v62, v63
    v_max3_f32 v153, |v60|, |v61|, v153
    v_max3_f32 v153, |v62|, |v63|, v153
    ds_write_b64 v111, v[74:75] offset:16928
    v_pk_mul_f32 v[64:65], v[64:65], s[86:87]
    v_pk_mul_f32 v[66:67], v[66:67], s[86:87]
    v_cvt_pk_bf16_f32 v76, v64, v65
    v_cvt_pk_bf16_f32 v77, v66, v67
    v_max3_f32 v153, |v64|, |v65|, v153
    v_max3_f32 v153, |v66|, |v67|, v153
    ds_write_b64 v111, v[76:77] offset:16944
    s_mov_b64 exec, -1
    s_waitcnt lgkmcnt(0)
    s_barrier
    ds_read_b128 v[4:7], v109 offset:0
    ds_read_b128 v[8:11], v109 offset:8448
    ds_read_b128 v[12:15], v109 offset:16896
    ds_read_b128 v[16:19], v109 offset:25344
    buffer_load_dwordx2 v[32:33], v152, s[32:35], s82 offen sc1
    s_movk_i32 s84, 0x2000
    s_movk_i32 s85, 0x4000
    s_movk_i32 s86, 0x6000
    s_waitcnt lgkmcnt(3)
    buffer_store_dwordx4 v[4:7], v110, s[64:67], 0 offen sc1
    s_waitcnt lgkmcnt(2)
    buffer_store_dwordx4 v[8:11], v110, s[64:67], s84 offen sc1
    s_waitcnt lgkmcnt(1)
    buffer_store_dwordx4 v[12:15], v110, s[64:67], s85 offen sc1
    s_cmp_lg_u32 s24, 0
    s_cbranch_scc1 K_PST
    s_waitcnt lgkmcnt(0)
    buffer_store_dwordx4 v[16:19], v110, s[64:67], s86 offen sc1
K_PST:
    s_sub_u32 s88, s2, 250
    s_cmp_lt_u32 s88, 5
    s_cbranch_scc1 K_W2DX_O
K_W2DX:
    v_mov_b32 v104, 0x3f80
    v_mov_b32 v105, 0
    v_bfe_u32 v106, v0, 2, 2
    v_mul_u32_u24 v106, 40, v106
    v_and_b32 v106, 48, v106
    v_lshlrev_b64 v[106:107], v106, v[104:105]
    v_mov_b32 v104, 0
    ds_write_b128 v2, v[104:107] offset:14880
    ds_write_b128 v2, v[104:107] offset:23072
    ds_write_b128 v2, v[104:107] offset:31264
    ds_write_b128 v2, v[104:107] offset:39456
    ds_write_b128 v2, v[104:107] offset:47648
    v_mov_b32 v106, 0
    v_mov_b32 v107, 0
    s_mov_b32 s90, 0xbfb8aa3b
    v_lshlrev_b32 v124, 16, v124
    v_lshlrev_b32 v125, 16, v125
    v_lshlrev_b32 v126, 16, v126
    v_lshlrev_b32 v127, 16, v127
    v_lshlrev_b32 v128, 16, v128
    v_lshlrev_b32 v129, 16, v129
    v_lshlrev_b32 v130, 16, v130
    v_lshlrev_b32 v131, 16, v131
    v_lshlrev_b32 v132, 16, v132
    v_mul_f32 v124, s90, v124
    v_mul_f32 v125, s90, v125
    v_mul_f32 v126, s90, v126
    v_mul_f32 v127, s90, v127
    v_mul_f32 v128, s90, v128
    v_mul_f32 v129, s90, v129
    v_mul_f32 v130, s90, v130
    v_mul_f32 v131, s90, v131
    v_mul_f32 v132, s90, v132
    v_max3_f32 v119, |v124|, |v125|, |v126|
    v_max3_f32 v119, |v127|, |v128|, v119
    v_max3_f32 v119, |v129|, |v130|, v119
    v_max3_f32 v119, |v131|, |v131|, v119
    v_cvt_pk_bf16_f32 v124, v124, v125
    v_cvt_pk_bf16_f32 v125, v126, v127
    v_cvt_pk_bf16_f32 v128, v128, v129
    v_cvt_pk_bf16_f32 v129, v130, v131
    v_and_b32 v69, 1, v1
    v_max_u32_dpp v119, v119, v119 row_shr:1 row_mask:0xf bank_mask:0xf bound_ctrl:0
    v_max_u32_dpp v153, v153, v153 row_shr:1 row_mask:0xf bank_mask:0xf bound_ctrl:0
    v_lshrrev_b32 v72, 1, v0
    v_max_u32_dpp v119, v119, v119 row_shr:2 row_mask:0xf bank_mask:0xf bound_ctrl:0
    v_max_u32_dpp v153, v153, v153 row_shr:2 row_mask:0xf bank_mask:0xf bound_ctrl:0
    v_mul_u32_u24 v72, 1600, v72
    v_max_u32_dpp v119, v119, v119 row_shr:4 row_mask:0xf bank_mask:0xf bound_ctrl:0
    v_max_u32_dpp v153, v153, v153 row_shr:4 row_mask:0xf bank_mask:0xf bound_ctrl:0
    v_sub_u32 v83, 1, v69
    v_max_u32_dpp v119, v119, v119 row_shr:8 row_mask:0xf bank_mask:0xf bound_ctrl:0
    v_max_u32_dpp v153, v153, v153 row_shr:8 row_mask:0xf bank_mask:0xf bound_ctrl:0
    v_add_u32 v78, s31, v1
    v_max_u32_dpp v119, v119, v119 row_bcast:15 row_mask:0xa bank_mask:0xf
    v_max_u32_dpp v153, v153, v153 row_bcast:15 row_mask:0xa bank_mask:0xf
    v_mul_u32_u24 v78, 12, v78
    v_max_u32_dpp v119, v119, v119 row_bcast:31 row_mask:0xc bank_mask:0xf
    v_max_u32_dpp v153, v153, v153 row_bcast:31 row_mask:0xc bank_mask:0xf
    v_mul_f32 v119, 0x3f8147ae, v119
    v_mov_b32 v73, 0
    s_mov_b32 exec_lo, 0
    s_brev_b32 exec_hi, 1
    ds_max_u32 v73, v153 offset:13104
    s_mov_b64 exec, -1
    v_readlane_b32 s80, v119, 63
    v_add_u32 v79, 768, v78
    v_add_u32 v80, 1536, v78
    v_add_u32 v81, 2304, v78
    s_lshl_b32 s87, s24, 10
    s_add_u32 s87, s87, 55840
    v_lshl_add_u32 v82, v1, 2, s87
    s_lshl_b32 s88, s31, 2
    s_sub_u32 s88, s87, s88
    s_add_u32 s87, s31, 256
    s_movk_i32 s84, 30000
    s_waitcnt vmcnt(3)
K_POLL:
    v_xor_b32 v68, s58, v32
    v_xor_b32 v70, s59, v33
    v_lshrrev_b32 v70, 22, v70
    v_or_b32 v68, v68, v70
    v_cmpx_ne_u32 vcc, 0, v68
    s_sub_u32 s84, s84, 1
    s_cbranch_execz K_POLLE
    s_cmp_eq_u32 s84, 0
    s_cbranch_scc1 K_POLLE
    s_sleep 1
    buffer_load_dwordx2 v[32:33], v152, s[32:35], s82 offen sc1
    s_waitcnt vmcnt(0)
    s_branch K_POLL
K_POLLE:
    s_mov_b64 exec, -1
    v_mov_b32 v157, v33
K_POLLD:
    v_bfe_u32 v68, v157, 11, 11
    v_mul_u32_u24 v70, v68, v83
    v_and_b32 v73, 0x7ff, v157
    v_add_u32 v72, v72, v73
    s_nop 0
    v_add_u32_dpp v70, v70, v70 row_shr:1 row_mask:0xf bank_mask:0xf bound_ctrl:0
    s_nop 1
    v_add_u32_dpp v70, v70, v70 row_shr:2 row_mask:0xf bank_mask:0xf bound_ctrl:0
    s_nop 1
    v_add_u32_dpp v70, v70, v70 row_shr:4 row_mask:0xf bank_mask:0xf bound_ctrl:0
    s_nop 1
    v_add_u32_dpp v70, v70, v70 row_shr:8 row_mask:0xf bank_mask:0xf bound_ctrl:0
    s_nop 1
    v_add_u32_dpp v70, v70, v70 row_bcast:15 row_mask:0xa bank_mask:0xf
    s_nop 1
    v_add_u32_dpp v70, v70, v70 row_bcast:31 row_mask:0xc bank_mask:0xf
    v_sub_u32 v71, v70, v68
    v_readlane_b32 s30, v70, 63
    v_sub_u32 v72, v72, v71
    v_max_u32 v71, s31, v71
    v_add_u32 v71, v71, v69
    v_min_u32 v70, s87, v70
    v_lshl_add_u32 v73, v71, 2, s88
    v_sub_u32 v70, v70, v71
    v_mul_i32_i24 v72, 12, v72
K_EXP:
    v_cmpx_lt_i32 vcc, 0, v70
    ds_write_b32 v73, v72 offset:0
    v_cmpx_lt_i32 vcc, 2, v70
    ds_write_b32 v73, v72 offset:8
    v_cmpx_lt_i32 vcc, 4, v70
    ds_write_b32 v73, v72 offset:16
    v_cmpx_lt_i32 vcc, 6, v70
    ds_write_b32 v73, v72 offset:24
    v_cmpx_lt_i32 vcc, 8, v70
    ds_write_b32 v73, v72 offset:32
    v_cmpx_lt_i32 vcc, 10, v70
    ds_write_b32 v73, v72 offset:40
    v_cmpx_lt_i32 vcc, 12, v70
    ds_write_b32 v73, v72 offset:48
    v_cmpx_lt_i32 vcc, 14, v70
    ds_write_b32 v73, v72 offset:56
    v_cmpx_lt_i32 vcc, 16, v70
    s_cbranch_execz K_EXPD
    v_subrev_u32 v70, 16, v70
    v_add_u32 v73, 64, v73
    s_branch K_EXP
K_EXPD:
    s_mov_b64 exec, -1
    ds_read_b32 v74, v82 offset:0
    ds_read_b32 v75, v82 offset:256
    ds_read_b32 v76, v82 offset:512
    ds_read_b32 v77, v82 offset:768
    s_mul_i32 s87, s30, 12
    v_bfrev_b32 v72, 2
    s_mov_b32 s86, 8388608
    v_cmp_gt_u32 s[72:73], s87, v78
    v_cmp_gt_u32 s[74:75], s87, v79
    v_cmp_gt_u32 s[76:77], s87, v80
    v_cmp_gt_u32 s[78:79], s87, v81
    s_waitcnt lgkmcnt(3)
    v_add_u32 v78, v78, v74
    v_cndmask_b32 v78, v72, v78, s[72:73]
    buffer_load_dwordx3 v[84:86], v78, s[32:35], s86 offen sc1
    s_waitcnt lgkmcnt(2)
    v_add_u32 v79, v79, v75
    v_cndmask_b32 v79, v72, v79, s[74:75]
    buffer_load_dwordx3 v[88:90], v79, s[32:35], s86 offen sc1
    s_waitcnt lgkmcnt(1)
    v_add_u32 v80, v80, v76
    v_cndmask_b32 v80, v72, v80, s[76:77]
    buffer_load_dwordx3 v[92:94], v80, s[32:35], s86 offen sc1
    s_waitcnt lgkmcnt(0)
    v_add_u32 v81, v81, v77
    v_cndmask_b32 v81, v72, v81, s[78:79]
    buffer_load_dwordx3 v[96:98], v81, s[32:35], s86 offen sc1
    s_waitcnt vmcnt(4)
    s_barrier
    s_cmp_lg_u32 s29, 0
    s_cbranch_scc1 K_HIST
    s_cmp_lg_u32 s24, 1
    s_cbranch_scc1 K_ARRD
    s_lshl_b32 s84, s2, 6
    s_add_u32 s84, s84, s83
    v_mov_b32 v71, 0
    ds_read_b32 v70, v71 offset:13104
    v_mov_b32 v68, s58
    v_mov_b32 v69, s59
    v_lshlrev_b32 v72, 4, v1
    s_waitcnt lgkmcnt(0)
    s_mov_b64 exec, 15
    buffer_store_dwordx4 v[68:71], v72, s[32:35], s84 offen sc1
    s_mov_b64 exec, -1
    s_nop 0
K_ARRD:
    ds_write_b128 v100, v[104:107] offset:55968
    ds_write_b128 v100, v[104:107] offset:55984
    v_mov_b32 v74, 0x3f80
    v_min_u32 v72, 4, v1
    v_lshlrev_b32 v72, 9, v72
    ds_write_b128 v72, v[104:107] offset:12800
    ds_write_b128 v104, v[104:107] offset:13136
    v_mfma_f32_32x32x16_bf16 v[4:19], v[104:107], v[104:107], 0
    v_mfma_f32_32x32x16_bf16 v[20:35], v[104:107], v[104:107], 0
    v_cmp_gt_u32 vcc, 48, v1
    s_cmp_eq_u32 s25, 0
    s_cselect_b64 exec, -1, vcc
    ds_write_b16 v101, v74 offset:55968
    s_mov_b64 exec, -1
    ds_write_b128 v102, v[104:107] offset:65248
    s_cmp_eq_u32 s24, 1
    s_cbranch_scc1 K_HIST2
K_HIST:
    s_waitcnt vmcnt(0)
K_HIST2:
    s_waitcnt vmcnt(1)
    v_mov_b32 v104, 1
    v_bfe_u32 v68, v86, 16, 6
    v_lshlrev_b32 v76, 2, v68
    v_bfe_u32 v69, v90, 16, 6
    v_lshlrev_b32 v77, 2, v69
    v_bfe_u32 v70, v94, 16, 6
    v_lshlrev_b32 v78, 2, v70
    v_bfe_u32 v71, v98, 16, 6
    v_lshlrev_b32 v79, 2, v71
    s_mov_b64 exec, s[72:73]
    ds_add_rtn_u32 v72, v76, v104 offset:12816
    s_mov_b64 exec, s[74:75]
    ds_add_rtn_u32 v73, v77, v104 offset:12816
    s_mov_b64 exec, s[76:77]
    ds_add_rtn_u32 v74, v78, v104 offset:12816
    s_mov_b64 exec, s[78:79]
    ds_add_rtn_u32 v75, v79, v104 offset:12816
    s_mov_b64 exec, -1
    v_mov_b32 v105, 4288567296
    v_and_b32 v80, 0x3fff, v86
    v_lshl_add_u32 v80, v80, 9, v105
    v_mul_u32_u24 v68, 192, v68
    v_and_b32 v81, 0x3fff, v90
    v_lshl_add_u32 v81, v81, 9, v105
    v_mul_u32_u24 v69, 192, v69
    v_and_b32 v82, 0x3fff, v94
    v_lshl_add_u32 v82, v82, 9, v105
    v_mul_u32_u24 v70, 192, v70
    v_and_b32 v83, 0x3fff, v98
    v_lshl_add_u32 v83, v83, 9, v105
    v_mul_u32_u24 v71, 192, v71
    v_lshlrev_b32 v104, 2, v1
    s_waitcnt lgkmcnt(0)
    s_barrier
    ds_read_b32 v105, v104 offset:12816
    s_lshl_b32 s84, s24, 6
    s_add_u32 s84, s84, 65536
    s_cmp_lg_u32 s29, 0
    s_cbranch_scc1 K_NOS1
    s_add_u32 m0, s44, 0
    s_add_u32 s85, s84, 0
    buffer_load_dwordx4 v144, s[60:63], s85 offen lds
    s_add_u32 m0, s44, 1024
    s_add_u32 s85, s84, 8192
    buffer_load_dwordx4 v144, s[60:63], s85 offen lds
    s_add_u32 m0, s44, 2048
    s_add_u32 s85, s84, 16384
    buffer_load_dwordx4 v144, s[60:63], s85 offen lds
    s_add_u32 m0, s44, 3072
    s_add_u32 s85, s84, 24576
    buffer_load_dwordx4 v144, s[60:63], s85 offen lds
    s_add_u32 m0, s44, 4160
    s_add_u32 s85, s84, 32768
    buffer_load_dwordx4 v144, s[60:63], s85 offen lds
K_NOS1:
    s_movk_i32 s92, -1040
    s_movk_i32 s93, -128
    v_cmp_lt_u32 vcc, 24, v1
    s_waitcnt lgkmcnt(0)
    v_mov_b32 v112, v105
    v_add_u32 v158, v158, v105
    v_add_u32 v105, 3, v105
    v_bfe_u32 v106, v105, 2, 1
    v_lshrrev_b32 v107, 3, v105
    v_lshl_or_b32 v105, v106, 16, v107
    v_mov_b32 v106, v105
    v_and_b32 v108, 3, v72
    v_cmp_eq_u32 s[52:53], 0, v108
    v_add_u32_dpp v106, v106, v106 row_shr:1 row_mask:0xf bank_mask:0xf bound_ctrl:0
    v_and_b32 v108, 3, v73
    v_cmp_eq_u32 s[54:55], 0, v108
    v_add_u32_dpp v106, v106, v106 row_shr:2 row_mask:0xf bank_mask:0xf bound_ctrl:0
    v_and_b32 v108, 3, v74
    v_cmp_eq_u32 s[64:65], 0, v108
    v_add_u32_dpp v106, v106, v106 row_shr:4 row_mask:0xf bank_mask:0xf bound_ctrl:0
    v_and_b32 v108, 3, v75
    v_cmp_eq_u32 s[66:67], 0, v108
    v_add_u32_dpp v106, v106, v106 row_shr:8 row_mask:0xf bank_mask:0xf bound_ctrl:0
    s_and_b64 s[52:53], s[52:53], s[72:73]
    s_and_b64 s[54:55], s[54:55], s[74:75]
    v_add_u32_dpp v106, v106, v106 row_bcast:15 row_mask:0xa bank_mask:0xf
    s_and_b64 s[64:65], s[64:65], s[76:77]
    s_and_b64 s[66:67], s[66:67], s[78:79]
    v_add_u32_dpp v106, v106, v106 row_bcast:31 row_mask:0xc bank_mask:0xf
    s_nop 0
    v_readlane_b32 s86, v106, 24
    v_readlane_b32 s87, v106, 63
    v_sub_u32 v106, v106, v105
    s_sub_u32 s87, s87, s86
    s_and_b32 s90, s86, 0xffff
    s_lshr_b32 s91, s86, 16
    s_lshl1_add_u32 s88, s90, s91
    s_add_u32 s88, s88, 7
    s_lshr_b32 s88, s88, 3
    s_add_u32 s89, s88, 3
    s_and_b32 s94, s87, 0xffff
    s_lshl_b32 s95, s90, 19
    s_lshl2_add_u32 s85, s89, s94
    s_lshl_b32 s85, s85, 1
    s_sub_u32 s85, s85, s91
    s_lshl_b32 s85, s85, 18
    s_lshl2_add_u32 s85, s89, s85
    s_sub_u32 s85, s85, s90
    v_mov_b32 v105, s85
    v_mov_b32 v110, s95
    v_cndmask_b32 v105, v110, v105, vcc
    v_and_b32 v110, 0xffff, v106
    v_lshrrev_b32 v106, 16, v106
    v_lshl_add_u32 v106, v106, 18, v110
    v_lshl_add_u32 v105, v107, 9, v105
    v_add_u32 v106, v106, v105
    ds_bpermute_b32 v76, v76, v106
    ds_bpermute_b32 v77, v77, v106
    ds_bpermute_b32 v78, v78, v106
    ds_bpermute_b32 v79, v79, v106
    s_cmp_lg_u32 s29, 0
    s_cbranch_scc1 K_NOS2
    s_add_u32 m0, s44, 5184
    s_add_u32 s85, s84, 40960
    buffer_load_dwordx4 v144, s[60:63], s85 offen lds
    s_add_u32 m0, s44, 6208
    s_add_u32 s85, s84, 49152
    buffer_load_dwordx4 v144, s[60:63], s85 offen lds
    s_add_u32 m0, s44, 7232
    s_add_u32 s85, s84, 57344
    buffer_load_dwordx4 v144, s[60:63], s85 offen lds
K_NOS2:
    s_lshr_b32 s87, s87, 16
    s_lshl1_add_u32 s87, s94, s87
    s_add_u32 s87, s87, 7
    s_lshr_b32 s87, s87, 3
    s_cmp_eq_u32 s25, 0
    s_cselect_b32 s46, s88, s87
    s_cselect_b32 s91, 0, s89
    s_cselect_b32 s81, s90, s94
    s_lshr_b32 s81, s81, 4
    s_lshl_b32 s94, s91, 9
    s_add_u32 s94, s94, 14880
    v_add_u32 v104, s94, v3
    v_mov_b32 v105, 12800
    v_cndmask_b32 v149, v105, v104, s[42:43]
    s_lshl_b32 s94, s91, 7
    s_add_u32 s94, s94, 2560
    v_add_u32 v151, s94, v148
    s_lshl_b32 s94, s91, 5
    v_add_u32 v152, s94, v159
    v_and_b32 v123, 255, v0
    v_lshlrev_b32 v123, 6, v123
    s_mov_b32 s85, s83
    s_cmp_lt_u32 s24, 4
    s_cbranch_scc1 K_PR1
    buffer_load_dwordx3 v[120:122], v123, s[32:35], s85 offen sc1
K_PR1:
    s_waitcnt lgkmcnt(0)
    s_mov_b64 exec, s[72:73]
    v_bfe_u32 v110, v76, 9, 9
    v_lshrrev_b32 v111, 18, v76
    v_and_b32 v76, 0x1ff, v76
    v_mad_i32_i24 v110, v110, -8, v72
    v_cmp_le_i32 vcc, 0, v110
    v_lshl_add_u32 v76, v76, 3, v72
    v_lshl_add_u32 v111, v111, 2, v110
    v_cndmask_b32 v76, v76, v111, vcc
    v_lshlrev_b32 v110, 4, v76
    v_lshlrev_b32 v111, 2, v76
    ds_write_b64 v110, v[84:85] offset:14880
    ds_add_u32 v111, v80 offset:2560
    s_mov_b64 exec, s[52:53]
    ds_write_b32 v76, v68 offset:0
    s_mov_b64 exec, -1
    s_cmp_lt_u32 s24, 4
    s_cbranch_scc0 K_FR1
    s_waitcnt vmcnt(4)
K_FR1:
    s_waitcnt vmcnt(5)
    ds_read_b64_tr_b16 v[160:161], v103 offset:0
    ds_read_b64_tr_b16 v[162:163], v103 offset:256
    ds_read_b64_tr_b16 v[164:165], v103 offset:1024
    ds_read_b64_tr_b16 v[166:167], v103 offset:1280
    ds_read_b64_tr_b16 v[168:169], v103 offset:2048
    ds_read_b64_tr_b16 v[170:171], v103 offset:2304
    ds_read_b64_tr_b16 v[172:173], v103 offset:3072
    ds_read_b64_tr_b16 v[174:175], v103 offset:3328
    s_mov_b64 exec, s[74:75]
    v_bfe_u32 v110, v77, 9, 9
    v_lshrrev_b32 v111, 18, v77
    v_and_b32 v77, 0x1ff, v77
    v_mad_i32_i24 v110, v110, -8, v73
    v_cmp_le_i32 vcc, 0, v110
    v_lshl_add_u32 v77, v77, 3, v73
    v_lshl_add_u32 v111, v111, 2, v110
    v_cndmask_b32 v77, v77, v111, vcc
    v_lshlrev_b32 v110, 4, v77
    v_lshlrev_b32 v111, 2, v77
    ds_write_b64 v110, v[88:89] offset:14880
    ds_add_u32 v111, v81 offset:2560
    s_mov_b64 exec, s[54:55]
    ds_write_b32 v77, v69 offset:0
    s_waitcnt lgkmcnt(3)
    s_mov_b64 exec, -1
    v_bfe_u32 v110, v78, 9, 9
    v_mfma_f32_32x32x16_bf16 v[36:51], v[192:195], v[160:163], 0
    v_lshrrev_b32 v111, 18, v78
    v_and_b32 v78, 0x1ff, v78
    v_mad_i32_i24 v110, v110, -8, v74
    v_mfma_f32_32x32x16_bf16 v[52:67], v[224:227], v[160:163], 0
    v_cmp_le_i32 vcc, 0, v110
    v_lshl_add_u32 v78, v78, 3, v74
    v_lshl_add_u32 v111, v111, 2, v110
    v_mfma_f32_32x32x16_bf16 v[36:51], v[196:199], v[164:167], v[36:51]
    v_cndmask_b32 v78, v78, v111, vcc
    v_lshlrev_b32 v110, 4, v78
    v_lshlrev_b32 v111, 2, v78
    v_mfma_f32_32x32x16_bf16 v[52:67], v[228:231], v[164:167], v[52:67]
    s_mov_b64 exec, s[76:77]
    ds_write_b64 v110, v[92:93] offset:14880
    ds_add_u32 v111, v82 offset:2560
    s_mov_b64 exec, s[64:65]
    ds_write_b32 v78, v70 offset:0
    s_mov_b64 exec, -1
    v_bfe_u32 v110, v79, 9, 9
    v_mfma_f32_32x32x16_bf16 v[36:51], v[200:203], v[168:171], v[36:51]
    v_lshrrev_b32 v111, 18, v79
    v_and_b32 v79, 0x1ff, v79
    v_mad_i32_i24 v110, v110, -8, v75
    v_mfma_f32_32x32x16_bf16 v[52:67], v[232:235], v[168:171], v[52:67]
    v_cmp_le_i32 vcc, 0, v110
    v_lshl_add_u32 v79, v79, 3, v75
    v_lshl_add_u32 v111, v111, 2, v110
    v_mfma_f32_32x32x16_bf16 v[36:51], v[204:207], v[172:175], v[36:51]
    v_cndmask_b32 v79, v79, v111, vcc
    v_lshlrev_b32 v110, 4, v79
    v_lshlrev_b32 v111, 2, v79
    v_mfma_f32_32x32x16_bf16 v[52:67], v[236:239], v[172:175], v[52:67]
    s_mov_b64 exec, s[78:79]
    ds_write_b64 v110, v[96:97] offset:14880
    ds_add_u32 v111, v83 offset:2560
    s_mov_b64 exec, s[66:67]
    ds_write_b32 v79, v71 offset:0
    s_mov_b64 exec, -1
    s_cmp_lg_u32 s24, 2
    s_cbranch_scc1 K_NOPAD
    v_bfe_u32 v110, v106, 9, 9
    v_lshrrev_b32 v111, 18, v106
    v_and_b32 v108, 0x1ff, v106
    v_mad_i32_i24 v110, v110, -8, v112
    v_lshl_add_u32 v108, v108, 3, v112
    v_cmp_le_i32 vcc, 0, v110
    v_lshl_add_u32 v111, v111, 2, v110
    v_and_b32 v112, 3, v112
    v_cndmask_b32 v108, v108, v111, vcc
    v_lshlrev_b32 v110, 4, v108
    v_mov_b32 v108, 0
    v_mov_b32 v109, 0
    v_cmpx_ne_u32 vcc, 0, v112
    ds_write_b64 v110, v[108:109] offset:14888
    v_cmpx_ne_u32 vcc, 3, v112
    ds_write_b64 v110, v[108:109] offset:14904
    v_cmpx_ne_u32 vcc, 2, v112
    ds_write_b64 v110, v[108:109] offset:14920
    s_mov_b64 exec, -1
K_NOPAD:
    s_cmp_ge_u32 s24, 2
    s_cbranch_scc1 K_NOPS
    s_cmp_eq_u32 s24, 0
    s_cselect_b32 s94, s88, s87
    s_cselect_b32 s95, 0, s89
    v_lshrrev_b32 v104, 5, v1
    v_add_u32 v104, s94, v104
    v_and_b32 v104, 1, v104
    v_and_b32 v105, 3, v1
    v_bfe_u32 v106, v1, 2, 2
    v_mul_u32_u24 v106, 5, v106
    v_bfe_u32 v106, v106, 1, 2
    v_lshrrev_b32 v107, 2, v1
    v_and_or_b32 v106, v107, 4, v106
    v_lshl_add_u32 v104, v104, 2, v105
    v_lshl_add_u32 v104, v104, 3, v106
    v_lshlrev_b32 v104, 9, v104
    v_mad_i32_i24 v104, v105, s92, v104
    v_mad_i32_i24 v104, v106, s93, v104
    s_add_u32 s94, s94, s95
    s_lshl_b32 s94, s94, 7
    s_lshl_b32 s95, s24, 15
    s_add_u32 s95, s95, 6406144
    v_add_u32 v104, s95, v104
    v_lshl_add_u32 v105, v1, 2, s94
    ds_write_b32 v105, v104 offset:2560
K_NOPS:
    v_mov_b32 v146, 0
    s_cmp_lt_u32 s24, 4
    s_cbranch_scc1 K_PR3
    s_cmp_lg_u32 s29, 0
    s_cbranch_scc1 K_PR3
    s_movk_i32 s84, 30000
K_PR2:
    s_waitcnt vmcnt(0)
    v_xor_b32 v104, s58, v120
    v_xor_b32 v105, s59, v121
    v_or_b32 v104, v104, v105
    v_cmpx_ne_u32 vcc, 0, v104
    s_sub_u32 s84, s84, 1
    s_cbranch_execz K_PR4
    s_cmp_eq_u32 s84, 0
    s_cbranch_scc1 K_PR4
    s_sleep 1
    buffer_load_dwordx3 v[120:122], v123, s[32:35], s85 offen sc1
    s_branch K_PR2
K_PR4:
    s_mov_b64 exec, -1
    v_mov_b32 v146, v122
K_PR3:
    s_waitcnt vmcnt(0) lgkmcnt(0)
    s_barrier
    v_mov_b32 v117, v146
    v_mov_b32 v155, 0
    v_mov_b32 v116, 0
    s_mov_b32 s86, 0xbfb8aa3b
    s_mov_b32 s87, 0xbfb8aa3b
    ds_read_b128 v[144:147], v151
    ds_read_b128 v[112:115], v151 offset:128
    ds_read_b32 v153, v152
    s_mov_b32 m0, s44
    s_waitcnt lgkmcnt(2)
    buffer_load_dwordx4 v144, s[48:51], 0 offen offset:0 sc1 lds
    buffer_load_dwordx4 v145, s[48:51], 0 offen offset:1040 sc1 lds
    buffer_load_dwordx4 v146, s[48:51], 0 offen offset:2080 sc1 lds
    buffer_load_dwordx4 v147, s[48:51], 0 offen offset:3120 sc1 lds
    ds_read_b64_tr_b16 v[176:177], v103 offset:4160
    ds_read_b64_tr_b16 v[178:179], v103 offset:4416
    ds_read_b64_tr_b16 v[180:181], v103 offset:5184
    ds_read_b64_tr_b16 v[182:183], v103 offset:5440
    ds_read_b64_tr_b16 v[184:185], v103 offset:6208
    ds_read_b64_tr_b16 v[186:187], v103 offset:6464
    ds_read_b64_tr_b16 v[188:189], v103 offset:7232
    ds_read_b64_tr_b16 v[190:191], v103 offset:7488
    v_lshlrev_b32 v104, 16, v84
    v_and_b32 v105, 0xffff0000, v84
    v_lshlrev_b32 v106, 16, v85
    v_and_b32 v107, 0xffff0000, v85
    s_waitcnt lgkmcnt(0)
    v_mfma_f32_32x32x16_bf16 v[36:51], v[208:211], v[176:179], v[36:51]
    v_add_f32_e64 v104, |v104|, |v105|
    v_add_f32_e64 v106, |v106|, |v107|
    v_add_f32 v104, v104, v106
    v_max_u32 v116, v116, v104
    v_lshlrev_b32 v104, 16, v88
    v_mfma_f32_32x32x16_bf16 v[36:51], v[212:215], v[180:183], v[36:51]
    v_and_b32 v105, 0xffff0000, v88
    v_lshlrev_b32 v106, 16, v89
    v_and_b32 v107, 0xffff0000, v89
    v_add_f32_e64 v104, |v104|, |v105|
    v_add_f32_e64 v106, |v106|, |v107|
    v_mfma_f32_32x32x16_bf16 v[36:51], v[216:219], v[184:187], v[36:51]
    v_add_f32 v104, v104, v106
    v_max_u32 v116, v116, v104
    v_lshlrev_b32 v104, 16, v92
    v_and_b32 v105, 0xffff0000, v92
    v_lshlrev_b32 v106, 16, v93
    v_mfma_f32_32x32x16_bf16 v[36:51], v[220:223], v[188:191], v[36:51]
    v_and_b32 v107, 0xffff0000, v93
    v_add_f32_e64 v104, |v104|, |v105|
    v_add_f32_e64 v106, |v106|, |v107|
    v_add_f32 v104, v104, v106
    v_max_u32 v116, v116, v104
    v_mfma_f32_32x32x16_bf16 v[52:67], v[240:243], v[176:179], v[52:67]
    v_lshlrev_b32 v104, 16, v96
    v_and_b32 v105, 0xffff0000, v96
    v_lshlrev_b32 v106, 16, v97
    v_and_b32 v107, 0xffff0000, v97
    v_add_f32_e64 v104, |v104|, |v105|
    v_mfma_f32_32x32x16_bf16 v[52:67], v[244:247], v[180:183], v[52:67]
    v_add_f32_e64 v106, |v106|, |v107|
    v_add_f32 v104, v104, v106
    v_max_u32 v116, v116, v104
    s_cmp_lg_u32 s29, 0
    s_cbranch_scc1 K_NOQ
    v_fma_f32 v36, v36, s86, v132
    v_mfma_f32_32x32x16_bf16 v[52:67], v[248:251], v[184:187], v[52:67]
    v_fma_f32 v37, v37, s86, v132
    v_cvt_pk_bf16_f32 v108, v36, v37
    v_max3_f32 v155, |v36|, |v37|, v155
    ds_write_b16 v154, v108 offset:0
    ds_write_b16_d16_hi v154, v108 offset:192
    v_mfma_f32_32x32x16_bf16 v[52:67], v[252:255], v[188:191], v[52:67]
    v_fma_f32 v38, v38, s86, v132
    v_fma_f32 v39, v39, s86, v132
    v_cvt_pk_bf16_f32 v109, v38, v39
    v_max3_f32 v155, |v38|, |v39|, v155
    ds_write_b16 v154, v109 offset:384
    ds_write_b16_d16_hi v154, v109 offset:576
    v_fma_f32 v40, v40, s86, v132
    v_fma_f32 v41, v41, s86, v132
    v_cvt_pk_bf16_f32 v108, v40, v41
    v_max3_f32 v155, |v40|, |v41|, v155
    ds_write_b16 v154, v108 offset:1536
    ds_write_b16_d16_hi v154, v108 offset:1728
    v_fma_f32 v42, v42, s86, v132
    v_fma_f32 v43, v43, s86, v132
    v_cvt_pk_bf16_f32 v109, v42, v43
    v_max3_f32 v155, |v42|, |v43|, v155
    ds_write_b16 v154, v109 offset:1920
    ds_write_b16_d16_hi v154, v109 offset:2112
    v_pk_fma_f32 v[44:45], v[44:45], s[86:87], v[132:133] op_sel_hi:[1,1,0]
    v_cvt_pk_bf16_f32 v108, v44, v45
    v_max3_f32 v155, |v44|, |v45|, v155
    ds_write_b16 v154, v108 offset:3072
    ds_write_b16_d16_hi v154, v108 offset:3264
    v_pk_fma_f32 v[46:47], v[46:47], s[86:87], v[132:133] op_sel_hi:[1,1,0]
    v_cvt_pk_bf16_f32 v109, v46, v47
    v_max3_f32 v155, |v46|, |v47|, v155
    ds_write_b16 v154, v109 offset:3456
    ds_write_b16_d16_hi v154, v109 offset:3648
    v_pk_fma_f32 v[48:49], v[48:49], s[86:87], v[132:133] op_sel_hi:[1,1,0]
    v_cvt_pk_bf16_f32 v108, v48, v49
    v_max3_f32 v155, |v48|, |v49|, v155
    ds_write_b16 v154, v108 offset:4608
    ds_write_b16_d16_hi v154, v108 offset:4800
    v_pk_fma_f32 v[50:51], v[50:51], s[86:87], v[132:133] op_sel_hi:[1,1,0]
    v_cvt_pk_bf16_f32 v109, v50, v51
    v_max3_f32 v155, |v50|, |v51|, v155
    ds_write_b16 v154, v109 offset:4992
    ds_write_b16_d16_hi v154, v109 offset:5184
    s_nop 1
    s_mov_b32 m0, s45
    s_nop 0
    buffer_load_dwordx4 v112, s[48:51], 0 offen offset:0 sc1 lds
    buffer_load_dwordx4 v113, s[48:51], 0 offen offset:1040 sc1 lds
    buffer_load_dwordx4 v114, s[48:51], 0 offen offset:2080 sc1 lds
    buffer_load_dwordx4 v115, s[48:51], 0 offen offset:3120 sc1 lds
    v_pk_fma_f32 v[52:53], v[52:53], s[86:87], v[132:133] op_sel_hi:[1,1,0]
    v_cvt_pk_bf16_f32 v108, v52, v53
    v_max3_f32 v155, |v52|, |v53|, v155
    ds_write_b16 v154, v108 offset:6144
    ds_write_b16_d16_hi v154, v108 offset:6336
    v_pk_fma_f32 v[54:55], v[54:55], s[86:87], v[132:133] op_sel_hi:[1,1,0]
    v_cvt_pk_bf16_f32 v109, v54, v55
    v_max3_f32 v155, |v54|, |v55|, v155
    ds_write_b16 v154, v109 offset:6528
    ds_write_b16_d16_hi v154, v109 offset:6720
    v_pk_fma_f32 v[56:57], v[56:57], s[86:87], v[132:133] op_sel_hi:[1,1,0]
    v_cvt_pk_bf16_f32 v108, v56, v57
    v_max3_f32 v155, |v56|, |v57|, v155
    ds_write_b16 v154, v108 offset:7680
    ds_write_b16_d16_hi v154, v108 offset:7872
    v_pk_fma_f32 v[58:59], v[58:59], s[86:87], v[132:133] op_sel_hi:[1,1,0]
    v_cvt_pk_bf16_f32 v109, v58, v59
    v_max3_f32 v155, |v58|, |v59|, v155
    ds_write_b16 v154, v109 offset:8064
    ds_write_b16_d16_hi v154, v109 offset:8256
    v_pk_fma_f32 v[60:61], v[60:61], s[86:87], v[132:133] op_sel_hi:[1,1,0]
    v_cvt_pk_bf16_f32 v108, v60, v61
    v_max3_f32 v155, |v60|, |v61|, v155
    s_mov_b32 exec_hi, 0
    ds_write_b16 v154, v108 offset:9216
    s_mov_b32 exec_hi, -1
    s_branch K_NOQ2
K_NOQ:
    s_mov_b32 m0, s45
    s_nop 0
    buffer_load_dwordx4 v112, s[48:51], 0 offen offset:0 sc1 lds
    buffer_load_dwordx4 v113, s[48:51], 0 offen offset:1040 sc1 lds
    buffer_load_dwordx4 v114, s[48:51], 0 offen offset:2080 sc1 lds
    buffer_load_dwordx4 v115, s[48:51], 0 offen offset:3120 sc1 lds
K_NOQ2:
    v_mov_b32 v118, v155
    s_nop 0
    v_and_b32 v104, 7, v1
    v_mul_u32_u24 v104, 1040, v104
    v_add_u32 v104, s44, v104
    v_mov_b32 v106, 0
    v_mov_b32 v107, 0
    ds_write_b64 v104, v[106:107] offset:1024
    v_max_u32_dpp v116, v116, v116 row_shr:1 row_mask:0xf bank_mask:0xf bound_ctrl:0
    v_max_u32_dpp v117, v117, v117 row_shr:1 row_mask:0xf bank_mask:0xf bound_ctrl:0
    v_max_u32_dpp v118, v118, v118 row_shr:1 row_mask:0xf bank_mask:0xf bound_ctrl:0
    v_max_u32_dpp v116, v116, v116 row_shr:2 row_mask:0xf bank_mask:0xf bound_ctrl:0
    v_max_u32_dpp v117, v117, v117 row_shr:2 row_mask:0xf bank_mask:0xf bound_ctrl:0
    v_max_u32_dpp v118, v118, v118 row_shr:2 row_mask:0xf bank_mask:0xf bound_ctrl:0
    v_max_u32_dpp v116, v116, v116 row_shr:4 row_mask:0xf bank_mask:0xf bound_ctrl:0
    v_max_u32_dpp v117, v117, v117 row_shr:4 row_mask:0xf bank_mask:0xf bound_ctrl:0
    v_max_u32_dpp v118, v118, v118 row_shr:4 row_mask:0xf bank_mask:0xf bound_ctrl:0
    v_max_u32_dpp v116, v116, v116 row_shr:8 row_mask:0xf bank_mask:0xf bound_ctrl:0
    v_max_u32_dpp v117, v117, v117 row_shr:8 row_mask:0xf bank_mask:0xf bound_ctrl:0
    v_max_u32_dpp v118, v118, v118 row_shr:8 row_mask:0xf bank_mask:0xf bound_ctrl:0
    v_max_u32_dpp v116, v116, v116 row_bcast:15 row_mask:0xa bank_mask:0xf
    v_max_u32_dpp v117, v117, v117 row_bcast:15 row_mask:0xa bank_mask:0xf
    v_max_u32_dpp v118, v118, v118 row_bcast:15 row_mask:0xa bank_mask:0xf
    v_max_u32_dpp v116, v116, v116 row_bcast:31 row_mask:0xc bank_mask:0xf
    v_max_u32_dpp v117, v117, v117 row_bcast:31 row_mask:0xc bank_mask:0xf
    v_max_u32_dpp v118, v118, v118 row_bcast:31 row_mask:0xc bank_mask:0xf
    s_add_u32 s88, s30, 255
    s_lshr_b32 s88, s88, 8
    v_mov_b32 v106, s88
    v_mov_b32 v107, 13136
    s_mov_b32 exec_lo, 0
    s_brev_b32 exec_hi, 1
    ds_max_u32 v107, v117
    ds_max_u32 v107, v118 offset:4
    ds_max_u32 v107, v116 offset:8
    ds_max_u32 v107, v106 offset:12
    s_mov_b64 exec, -1
    v_mov_b32 v132, 0
    v_mov_b32 v96, 0
    v_mov_b32 v100, 0
    v_mov_b32 v133, 0
    v_mov_b32 v97, 0
    v_mov_b32 v101, 0
    v_mov_b32 v134, 0
    v_mov_b32 v98, 0
    v_mov_b32 v102, 0
    v_mov_b32 v135, 0
    v_mov_b32 v99, 0
    v_mov_b32 v103, 0
    s_waitcnt lgkmcnt(0)
    v_add_u32 v154, v153, v156
    s_barrier
    ds_read_b128 v[68:71], v107
    ds_read_b128 v[120:123], v149
    ds_read_b64_tr_b16 v[126:127], v154
    ds_read_b64_tr_b16 v[130:131], v154 offset:64
    ds_read_b128 v[144:147], v151 offset:256
    ds_read_b32 v153, v152 offset:32
    s_waitcnt lgkmcnt(5)
    v_fma_f32 v69, v70, s80, v69
    v_add_f32 v68, v68, v69
    v_readfirstlane_b32 s47, v71
    v_readfirstlane_b32 s92, v68
    v_lshrrev_b32 v73, 5, v1
    v_bfe_u32 v76, v1, 3, 1
    v_bfe_u32 v77, v1, 2, 1
    v_lshl_or_b32 v76, v76, 2, v77
    v_lshl_or_b32 v76, v73, 1, v76
    s_lshl_b32 s88, s91, 5
    v_lshl_add_u32 v231, v76, 3, s88
    ds_read_b32 v232, v231
    s_waitcnt vmcnt(4)
    ds_read_b64_tr_b16 v[36:37], v136 offset:0
    ds_read_b64_tr_b16 v[38:39], v136 offset:1040
    ds_read_b64_tr_b16 v[40:41], v136 offset:2080
    ds_read_b64_tr_b16 v[42:43], v136 offset:3120
    ds_read_b64_tr_b16 v[44:45], v138 offset:0
    ds_read_b64_tr_b16 v[46:47], v138 offset:1040
    ds_read_b64_tr_b16 v[48:49], v138 offset:2080
    ds_read_b64_tr_b16 v[50:51], v138 offset:3120
    s_waitcnt lgkmcnt(0)
    v_mfma_f32_32x32x16_bf16 v[36:51], v[120:123], v[124:127], v[36:51]
    s_cmp_eq_u32 s46, 0
    s_cbranch_scc1 K_DONE
    s_nop 3
    s_cmp_le_u32 s92, 0x41f00000
    s_cbranch_scc0 K_LOOP_S
    s_cmp_le_u32 s92, 0x41700000
    s_cselect_b32 s81, s81, 0
    s_cmp_eq_u32 s81, 0
    s_cbranch_scc1 K_LOOP_F
    s_lshl_b32 s85, s81, 2
    s_sub_u32 s46, s46, s85
    .p2align 6
K_LOOP_8:
    s_setprio 3
    ds_read_b64_tr_b16 v[52:53], v137 offset:0
    ds_read_b64_tr_b16 v[54:55], v137 offset:1040
    ds_read_b64_tr_b16 v[56:57], v137 offset:2080
    ds_read_b64_tr_b16 v[58:59], v137 offset:3120
    ds_read_b64_tr_b16 v[60:61], v139 offset:0
    ds_read_b64_tr_b16 v[62:63], v139 offset:1040
    ds_read_b64_tr_b16 v[64:65], v139 offset:2080
    ds_read_b64_tr_b16 v[66:67], v139 offset:3120
    v_mfma_f32_32x32x16_bf16 v[20:35], v[100:103], v[132:135], v[20:35]
    v_exp_f32 v68, v36
    v_exp_f32 v69, v37
    v_exp_f32 v70, v38
    v_exp_f32 v71, v39
    v_exp_f32 v72, v40
    v_exp_f32 v73, v41
    v_exp_f32 v74, v42
    v_exp_f32 v75, v43
    v_exp_f32 v76, v44
    s_waitcnt lgkmcnt(0)
    v_mfma_f32_32x32x16_bf16 v[52:67], v[120:123], v[128:131], v[52:67]
    v_exp_f32 v77, v45
    v_exp_f32 v78, v46
    v_exp_f32 v79, v47
    v_exp_f32 v80, v48
    v_exp_f32 v81, v49
    v_exp_f32 v82, v50
    v_exp_f32 v83, v51
    v_pk_add_f32 v[88:89], v[68:69], s[40:41]
    s_mov_b32 m0, s44
    v_add_u32 v155, v153, v156
    v_pk_fma_f32 v[86:87], v[36:37], v[70:71], v[36:37]
    buffer_load_dwordx4 v144, s[48:51], 0 offen offset:0 sc1 lds
    v_pk_fma_f32 v[90:91], v[88:89], v[70:71], v[88:89]
    buffer_load_dwordx4 v145, s[48:51], 0 offen offset:1040 sc1 lds
    v_pk_fma_f32 v[84:85], v[38:39], v[88:89], v[86:87]
    buffer_load_dwordx4 v146, s[48:51], 0 offen offset:2080 sc1 lds
    v_pk_fma_f32 v[86:87], v[84:85], v[72:73], v[84:85]
    buffer_load_dwordx4 v147, s[48:51], 0 offen offset:3120 sc1 lds
    v_pk_fma_f32 v[88:89], v[90:91], v[72:73], v[90:91]
    ds_read_b128 v[120:123], v149 offset:512
    v_pk_fma_f32 v[84:85], v[40:41], v[90:91], v[86:87]
    ds_read_b64_tr_b16 v[126:127], v155 offset:0
    v_pk_fma_f32 v[86:87], v[84:85], v[74:75], v[84:85]
    ds_read_b64_tr_b16 v[130:131], v155 offset:64
    v_pk_fma_f32 v[90:91], v[88:89], v[74:75], v[88:89]
    ds_read_b32 v153, v152 offset:64
    v_pk_fma_f32 v[84:85], v[42:43], v[88:89], v[86:87]
    v_add_u32 v232, v232, v156
    v_pk_fma_f32 v[86:87], v[84:85], v[76:77], v[84:85]
    ds_read_b64_tr_b16 v[132:133], v232 offset:128
    v_pk_fma_f32 v[88:89], v[90:91], v[76:77], v[90:91]
    v_pk_fma_f32 v[84:85], v[44:45], v[90:91], v[86:87]
    v_pk_fma_f32 v[86:87], v[84:85], v[78:79], v[84:85]
    v_pk_fma_f32 v[90:91], v[88:89], v[78:79], v[88:89]
    v_pk_fma_f32 v[84:85], v[46:47], v[88:89], v[86:87]
    v_pk_fma_f32 v[86:87], v[84:85], v[80:81], v[84:85]
    v_pk_fma_f32 v[88:89], v[90:91], v[80:81], v[90:91]
    v_pk_fma_f32 v[84:85], v[48:49], v[90:91], v[86:87]
    v_pk_fma_f32 v[86:87], v[84:85], v[82:83], v[84:85]
    v_pk_fma_f32 v[90:91], v[88:89], v[82:83], v[88:89]
    v_rcp_f32 v92, v90
    v_rcp_f32 v93, v91
    v_pk_fma_f32 v[84:85], v[50:51], v[88:89], v[86:87]
    v_pk_mul_f32 v[84:85], v[84:85], v[92:93]
    v_cvt_pk_bf16_f32 v96, v84, v85
    s_setprio 2
    s_waitcnt vmcnt(4)
    ds_read_b64_tr_b16 v[36:37], v136 offset:4160
    ds_read_b64_tr_b16 v[38:39], v136 offset:5200
    ds_read_b64_tr_b16 v[40:41], v136 offset:6240
    ds_read_b64_tr_b16 v[42:43], v136 offset:7280
    ds_read_b64_tr_b16 v[44:45], v138 offset:4160
    ds_read_b64_tr_b16 v[46:47], v138 offset:5200
    ds_read_b64_tr_b16 v[48:49], v138 offset:6240
    ds_read_b64_tr_b16 v[50:51], v138 offset:7280
    v_exp_f32 v68, v52
    v_exp_f32 v69, v53
    v_exp_f32 v70, v54
    v_exp_f32 v71, v55
    v_exp_f32 v72, v56
    v_exp_f32 v73, v57
    v_exp_f32 v74, v58
    v_exp_f32 v75, v59
    v_exp_f32 v76, v60
    s_waitcnt lgkmcnt(0)
    v_mfma_f32_32x32x16_bf16 v[36:51], v[120:123], v[124:127], v[36:51]
    v_exp_f32 v77, v61
    v_exp_f32 v78, v62
    v_exp_f32 v79, v63
    v_exp_f32 v80, v64
    v_exp_f32 v81, v65
    v_exp_f32 v82, v66
    v_exp_f32 v83, v67
    v_pk_add_f32 v[88:89], v[68:69], s[40:41]
    ds_read_b128 v[144:147], v151 offset:384
    v_pk_fma_f32 v[86:87], v[52:53], v[70:71], v[52:53]
    v_pk_fma_f32 v[90:91], v[88:89], v[70:71], v[88:89]
    v_pk_fma_f32 v[84:85], v[54:55], v[88:89], v[86:87]
    v_pk_fma_f32 v[86:87], v[84:85], v[72:73], v[84:85]
    v_pk_fma_f32 v[88:89], v[90:91], v[72:73], v[90:91]
    v_pk_fma_f32 v[84:85], v[56:57], v[90:91], v[86:87]
    v_pk_fma_f32 v[86:87], v[84:85], v[74:75], v[84:85]
    v_pk_fma_f32 v[90:91], v[88:89], v[74:75], v[88:89]
    v_pk_fma_f32 v[84:85], v[58:59], v[88:89], v[86:87]
    v_pk_fma_f32 v[86:87], v[84:85], v[76:77], v[84:85]
    v_pk_fma_f32 v[88:89], v[90:91], v[76:77], v[90:91]
    v_pk_fma_f32 v[84:85], v[60:61], v[90:91], v[86:87]
    v_pk_fma_f32 v[86:87], v[84:85], v[78:79], v[84:85]
    v_pk_fma_f32 v[90:91], v[88:89], v[78:79], v[88:89]
    v_pk_fma_f32 v[84:85], v[62:63], v[88:89], v[86:87]
    v_pk_fma_f32 v[86:87], v[84:85], v[80:81], v[84:85]
    v_pk_fma_f32 v[88:89], v[90:91], v[80:81], v[90:91]
    v_pk_fma_f32 v[84:85], v[64:65], v[90:91], v[86:87]
    v_pk_fma_f32 v[86:87], v[84:85], v[82:83], v[84:85]
    v_pk_fma_f32 v[90:91], v[88:89], v[82:83], v[88:89]
    v_rcp_f32 v92, v90
    v_rcp_f32 v93, v91
    v_pk_fma_f32 v[84:85], v[66:67], v[88:89], v[86:87]
    v_pk_mul_f32 v[84:85], v[84:85], v[92:93]
    v_cvt_pk_bf16_f32 v100, v84, v85
    s_setprio 1
    ds_read_b64_tr_b16 v[52:53], v137 offset:4160
    ds_read_b64_tr_b16 v[54:55], v137 offset:5200
    ds_read_b64_tr_b16 v[56:57], v137 offset:6240
    ds_read_b64_tr_b16 v[58:59], v137 offset:7280
    ds_read_b64_tr_b16 v[60:61], v139 offset:4160
    ds_read_b64_tr_b16 v[62:63], v139 offset:5200
    ds_read_b64_tr_b16 v[64:65], v139 offset:6240
    ds_read_b64_tr_b16 v[66:67], v139 offset:7280
    v_exp_f32 v68, v36
    v_exp_f32 v69, v37
    v_exp_f32 v70, v38
    v_exp_f32 v71, v39
    v_exp_f32 v72, v40
    v_exp_f32 v73, v41
    v_exp_f32 v74, v42
    v_exp_f32 v75, v43
    v_exp_f32 v76, v44
    s_waitcnt lgkmcnt(0)
    v_mfma_f32_32x32x16_bf16 v[52:67], v[120:123], v[128:131], v[52:67]
    v_exp_f32 v77, v45
    v_exp_f32 v78, v46
    v_exp_f32 v79, v47
    v_exp_f32 v80, v48
    v_exp_f32 v81, v49
    v_exp_f32 v82, v50
    v_exp_f32 v83, v51
    v_pk_add_f32 v[88:89], v[68:69], s[40:41]
    s_mov_b32 m0, s45
    v_add_u32 v154, v153, v156
    v_pk_fma_f32 v[86:87], v[36:37], v[70:71], v[36:37]
    buffer_load_dwordx4 v144, s[48:51], 0 offen offset:0 sc1 lds
    v_pk_fma_f32 v[90:91], v[88:89], v[70:71], v[88:89]
    buffer_load_dwordx4 v145, s[48:51], 0 offen offset:1040 sc1 lds
    v_pk_fma_f32 v[84:85], v[38:39], v[88:89], v[86:87]
    buffer_load_dwordx4 v146, s[48:51], 0 offen offset:2080 sc1 lds
    v_pk_fma_f32 v[86:87], v[84:85], v[72:73], v[84:85]
    buffer_load_dwordx4 v147, s[48:51], 0 offen offset:3120 sc1 lds
    v_pk_fma_f32 v[88:89], v[90:91], v[72:73], v[90:91]
    ds_read_b128 v[120:123], v149 offset:1024
    v_pk_fma_f32 v[84:85], v[40:41], v[90:91], v[86:87]
    ds_read_b64_tr_b16 v[126:127], v154 offset:0
    v_pk_fma_f32 v[86:87], v[84:85], v[74:75], v[84:85]
    ds_read_b64_tr_b16 v[130:131], v154 offset:64
    v_pk_fma_f32 v[90:91], v[88:89], v[74:75], v[88:89]
    ds_read_b32 v153, v152 offset:96
    v_pk_fma_f32 v[84:85], v[42:43], v[88:89], v[86:87]
    ds_read_b32 v232, v231 offset:64
    v_pk_fma_f32 v[86:87], v[84:85], v[76:77], v[84:85]
    v_pk_fma_f32 v[88:89], v[90:91], v[76:77], v[90:91]
    v_pk_fma_f32 v[84:85], v[44:45], v[90:91], v[86:87]
    v_pk_fma_f32 v[86:87], v[84:85], v[78:79], v[84:85]
    v_pk_fma_f32 v[90:91], v[88:89], v[78:79], v[88:89]
    v_pk_fma_f32 v[84:85], v[46:47], v[88:89], v[86:87]
    v_pk_fma_f32 v[86:87], v[84:85], v[80:81], v[84:85]
    v_pk_fma_f32 v[88:89], v[90:91], v[80:81], v[90:91]
    v_pk_fma_f32 v[84:85], v[48:49], v[90:91], v[86:87]
    v_pk_fma_f32 v[86:87], v[84:85], v[82:83], v[84:85]
    v_pk_fma_f32 v[90:91], v[88:89], v[82:83], v[88:89]
    v_rcp_f32 v92, v90
    v_rcp_f32 v93, v91
    v_pk_fma_f32 v[84:85], v[50:51], v[88:89], v[86:87]
    v_pk_mul_f32 v[84:85], v[84:85], v[92:93]
    v_cvt_pk_bf16_f32 v97, v84, v85
    s_setprio 0
    s_waitcnt vmcnt(4)
    ds_read_b64_tr_b16 v[36:37], v136 offset:0
    ds_read_b64_tr_b16 v[38:39], v136 offset:1040
    ds_read_b64_tr_b16 v[40:41], v136 offset:2080
    ds_read_b64_tr_b16 v[42:43], v136 offset:3120
    ds_read_b64_tr_b16 v[44:45], v138 offset:0
    ds_read_b64_tr_b16 v[46:47], v138 offset:1040
    ds_read_b64_tr_b16 v[48:49], v138 offset:2080
    ds_read_b64_tr_b16 v[50:51], v138 offset:3120
    v_exp_f32 v68, v52
    v_exp_f32 v69, v53
    v_exp_f32 v70, v54
    v_exp_f32 v71, v55
    v_exp_f32 v72, v56
    v_exp_f32 v73, v57
    v_exp_f32 v74, v58
    v_exp_f32 v75, v59
    v_exp_f32 v76, v60
    s_waitcnt lgkmcnt(0)
    v_mfma_f32_32x32x16_bf16 v[36:51], v[120:123], v[124:127], v[36:51]
    v_exp_f32 v77, v61
    v_exp_f32 v78, v62
    v_exp_f32 v79, v63
    v_exp_f32 v80, v64
    v_exp_f32 v81, v65
    v_exp_f32 v82, v66
    v_exp_f32 v83, v67
    v_pk_add_f32 v[88:89], v[68:69], s[40:41]
    ds_read_b128 v[144:147], v151 offset:512
    v_pk_fma_f32 v[86:87], v[52:53], v[70:71], v[52:53]
    v_pk_fma_f32 v[90:91], v[88:89], v[70:71], v[88:89]
    v_pk_fma_f32 v[84:85], v[54:55], v[88:89], v[86:87]
    v_pk_fma_f32 v[86:87], v[84:85], v[72:73], v[84:85]
    v_pk_fma_f32 v[88:89], v[90:91], v[72:73], v[90:91]
    v_pk_fma_f32 v[84:85], v[56:57], v[90:91], v[86:87]
    v_pk_fma_f32 v[86:87], v[84:85], v[74:75], v[84:85]
    v_pk_fma_f32 v[90:91], v[88:89], v[74:75], v[88:89]
    v_pk_fma_f32 v[84:85], v[58:59], v[88:89], v[86:87]
    v_pk_fma_f32 v[86:87], v[84:85], v[76:77], v[84:85]
    v_pk_fma_f32 v[88:89], v[90:91], v[76:77], v[90:91]
    v_pk_fma_f32 v[84:85], v[60:61], v[90:91], v[86:87]
    v_pk_fma_f32 v[86:87], v[84:85], v[78:79], v[84:85]
    v_pk_fma_f32 v[90:91], v[88:89], v[78:79], v[88:89]
    v_pk_fma_f32 v[84:85], v[62:63], v[88:89], v[86:87]
    v_pk_fma_f32 v[86:87], v[84:85], v[80:81], v[84:85]
    v_pk_fma_f32 v[88:89], v[90:91], v[80:81], v[90:91]
    v_pk_fma_f32 v[84:85], v[64:65], v[90:91], v[86:87]
    v_pk_fma_f32 v[86:87], v[84:85], v[82:83], v[84:85]
    v_pk_fma_f32 v[90:91], v[88:89], v[82:83], v[88:89]
    v_rcp_f32 v92, v90
    v_rcp_f32 v93, v91
    v_pk_fma_f32 v[84:85], v[66:67], v[88:89], v[86:87]
    v_pk_mul_f32 v[84:85], v[84:85], v[92:93]
    v_cvt_pk_bf16_f32 v101, v84, v85
    s_setprio 3
    ds_read_b64_tr_b16 v[52:53], v137 offset:0
    ds_read_b64_tr_b16 v[54:55], v137 offset:1040
    ds_read_b64_tr_b16 v[56:57], v137 offset:2080
    ds_read_b64_tr_b16 v[58:59], v137 offset:3120
    ds_read_b64_tr_b16 v[60:61], v139 offset:0
    ds_read_b64_tr_b16 v[62:63], v139 offset:1040
    ds_read_b64_tr_b16 v[64:65], v139 offset:2080
    ds_read_b64_tr_b16 v[66:67], v139 offset:3120
    v_exp_f32 v68, v36
    v_exp_f32 v69, v37
    v_exp_f32 v70, v38
    v_exp_f32 v71, v39
    v_exp_f32 v72, v40
    v_exp_f32 v73, v41
    v_exp_f32 v74, v42
    v_exp_f32 v75, v43
    v_exp_f32 v76, v44
    s_waitcnt lgkmcnt(0)
    v_mfma_f32_32x32x16_bf16 v[52:67], v[120:123], v[128:131], v[52:67]
    v_exp_f32 v77, v45
    v_exp_f32 v78, v46
    v_exp_f32 v79, v47
    v_exp_f32 v80, v48
    v_exp_f32 v81, v49
    v_exp_f32 v82, v50
    v_exp_f32 v83, v51
    v_pk_add_f32 v[88:89], v[68:69], s[40:41]
    s_mov_b32 m0, s44
    v_add_u32 v155, v153, v156
    v_pk_fma_f32 v[86:87], v[36:37], v[70:71], v[36:37]
    buffer_load_dwordx4 v144, s[48:51], 0 offen offset:0 sc1 lds
    v_pk_fma_f32 v[90:91], v[88:89], v[70:71], v[88:89]
    buffer_load_dwordx4 v145, s[48:51], 0 offen offset:1040 sc1 lds
    v_pk_fma_f32 v[84:85], v[38:39], v[88:89], v[86:87]
    buffer_load_dwordx4 v146, s[48:51], 0 offen offset:2080 sc1 lds
    v_pk_fma_f32 v[86:87], v[84:85], v[72:73], v[84:85]
    buffer_load_dwordx4 v147, s[48:51], 0 offen offset:3120 sc1 lds
    v_pk_fma_f32 v[88:89], v[90:91], v[72:73], v[90:91]
    ds_read_b128 v[120:123], v149 offset:1536
    v_pk_fma_f32 v[84:85], v[40:41], v[90:91], v[86:87]
    ds_read_b64_tr_b16 v[126:127], v155 offset:0
    v_pk_fma_f32 v[86:87], v[84:85], v[74:75], v[84:85]
    ds_read_b64_tr_b16 v[130:131], v155 offset:64
    v_pk_fma_f32 v[90:91], v[88:89], v[74:75], v[88:89]
    ds_read_b32 v153, v152 offset:128
    v_pk_fma_f32 v[84:85], v[42:43], v[88:89], v[86:87]
    v_add_u32 v232, v232, v156
    v_pk_fma_f32 v[86:87], v[84:85], v[76:77], v[84:85]
    ds_read_b64_tr_b16 v[134:135], v232 offset:128
    v_pk_fma_f32 v[88:89], v[90:91], v[76:77], v[90:91]
    v_pk_fma_f32 v[84:85], v[44:45], v[90:91], v[86:87]
    v_pk_fma_f32 v[86:87], v[84:85], v[78:79], v[84:85]
    v_pk_fma_f32 v[90:91], v[88:89], v[78:79], v[88:89]
    v_pk_fma_f32 v[84:85], v[46:47], v[88:89], v[86:87]
    v_pk_fma_f32 v[86:87], v[84:85], v[80:81], v[84:85]
    v_pk_fma_f32 v[88:89], v[90:91], v[80:81], v[90:91]
    v_pk_fma_f32 v[84:85], v[48:49], v[90:91], v[86:87]
    v_pk_fma_f32 v[86:87], v[84:85], v[82:83], v[84:85]
    v_pk_fma_f32 v[90:91], v[88:89], v[82:83], v[88:89]
    v_rcp_f32 v92, v90
    v_rcp_f32 v93, v91
    v_pk_fma_f32 v[84:85], v[50:51], v[88:89], v[86:87]
    v_pk_mul_f32 v[84:85], v[84:85], v[92:93]
    v_cvt_pk_bf16_f32 v98, v84, v85
    s_setprio 2
    s_waitcnt vmcnt(4)
    ds_read_b64_tr_b16 v[36:37], v136 offset:4160
    ds_read_b64_tr_b16 v[38:39], v136 offset:5200
    ds_read_b64_tr_b16 v[40:41], v136 offset:6240
    ds_read_b64_tr_b16 v[42:43], v136 offset:7280
    ds_read_b64_tr_b16 v[44:45], v138 offset:4160
    ds_read_b64_tr_b16 v[46:47], v138 offset:5200
    ds_read_b64_tr_b16 v[48:49], v138 offset:6240
    ds_read_b64_tr_b16 v[50:51], v138 offset:7280
    v_exp_f32 v68, v52
    v_exp_f32 v69, v53
    v_exp_f32 v70, v54
    v_exp_f32 v71, v55
    v_exp_f32 v72, v56
    v_exp_f32 v73, v57
    v_exp_f32 v74, v58
    v_exp_f32 v75, v59
    v_exp_f32 v76, v60
    s_waitcnt lgkmcnt(0)
    v_mfma_f32_32x32x16_bf16 v[36:51], v[120:123], v[124:127], v[36:51]
    v_exp_f32 v77, v61
    v_exp_f32 v78, v62
    v_exp_f32 v79, v63
    v_exp_f32 v80, v64
    v_exp_f32 v81, v65
    v_exp_f32 v82, v66
    v_exp_f32 v83, v67
    v_pk_add_f32 v[88:89], v[68:69], s[40:41]
    ds_read_b128 v[144:147], v151 offset:640
    v_pk_fma_f32 v[86:87], v[52:53], v[70:71], v[52:53]
    v_pk_fma_f32 v[90:91], v[88:89], v[70:71], v[88:89]
    v_pk_fma_f32 v[84:85], v[54:55], v[88:89], v[86:87]
    v_pk_fma_f32 v[86:87], v[84:85], v[72:73], v[84:85]
    v_pk_fma_f32 v[88:89], v[90:91], v[72:73], v[90:91]
    v_pk_fma_f32 v[84:85], v[56:57], v[90:91], v[86:87]
    v_pk_fma_f32 v[86:87], v[84:85], v[74:75], v[84:85]
    v_pk_fma_f32 v[90:91], v[88:89], v[74:75], v[88:89]
    v_pk_fma_f32 v[84:85], v[58:59], v[88:89], v[86:87]
    v_pk_fma_f32 v[86:87], v[84:85], v[76:77], v[84:85]
    v_pk_fma_f32 v[88:89], v[90:91], v[76:77], v[90:91]
    v_pk_fma_f32 v[84:85], v[60:61], v[90:91], v[86:87]
    v_pk_fma_f32 v[86:87], v[84:85], v[78:79], v[84:85]
    v_pk_fma_f32 v[90:91], v[88:89], v[78:79], v[88:89]
    v_pk_fma_f32 v[84:85], v[62:63], v[88:89], v[86:87]
    v_pk_fma_f32 v[86:87], v[84:85], v[80:81], v[84:85]
    v_pk_fma_f32 v[88:89], v[90:91], v[80:81], v[90:91]
    v_pk_fma_f32 v[84:85], v[64:65], v[90:91], v[86:87]
    v_pk_fma_f32 v[86:87], v[84:85], v[82:83], v[84:85]
    v_pk_fma_f32 v[90:91], v[88:89], v[82:83], v[88:89]
    v_rcp_f32 v92, v90
    v_rcp_f32 v93, v91
    v_pk_fma_f32 v[84:85], v[66:67], v[88:89], v[86:87]
    v_pk_mul_f32 v[84:85], v[84:85], v[92:93]
    v_cvt_pk_bf16_f32 v102, v84, v85
    s_setprio 1
    ds_read_b64_tr_b16 v[52:53], v137 offset:4160
    ds_read_b64_tr_b16 v[54:55], v137 offset:5200
    ds_read_b64_tr_b16 v[56:57], v137 offset:6240
    ds_read_b64_tr_b16 v[58:59], v137 offset:7280
    ds_read_b64_tr_b16 v[60:61], v139 offset:4160
    ds_read_b64_tr_b16 v[62:63], v139 offset:5200
    ds_read_b64_tr_b16 v[64:65], v139 offset:6240
    ds_read_b64_tr_b16 v[66:67], v139 offset:7280
    v_exp_f32 v68, v36
    v_exp_f32 v69, v37
    v_exp_f32 v70, v38
    v_exp_f32 v71, v39
    v_exp_f32 v72, v40
    v_exp_f32 v73, v41
    v_exp_f32 v74, v42
    v_exp_f32 v75, v43
    v_exp_f32 v76, v44
    s_waitcnt lgkmcnt(0)
    v_mfma_f32_32x32x16_bf16 v[52:67], v[120:123], v[128:131], v[52:67]
    v_exp_f32 v77, v45
    v_exp_f32 v78, v46
    v_exp_f32 v79, v47
    v_exp_f32 v80, v48
    v_exp_f32 v81, v49
    v_exp_f32 v82, v50
    v_exp_f32 v83, v51
    v_pk_add_f32 v[88:89], v[68:69], s[40:41]
    s_mov_b32 m0, s45
    v_add_u32 v154, v153, v156
    v_pk_fma_f32 v[86:87], v[36:37], v[70:71], v[36:37]
    buffer_load_dwordx4 v144, s[48:51], 0 offen offset:0 sc1 lds
    v_pk_fma_f32 v[90:91], v[88:89], v[70:71], v[88:89]
    buffer_load_dwordx4 v145, s[48:51], 0 offen offset:1040 sc1 lds
    v_pk_fma_f32 v[84:85], v[38:39], v[88:89], v[86:87]
    buffer_load_dwordx4 v146, s[48:51], 0 offen offset:2080 sc1 lds
    v_pk_fma_f32 v[86:87], v[84:85], v[72:73], v[84:85]
    buffer_load_dwordx4 v147, s[48:51], 0 offen offset:3120 sc1 lds
    v_pk_fma_f32 v[88:89], v[90:91], v[72:73], v[90:91]
    ds_read_b128 v[120:123], v149 offset:2048
    v_pk_fma_f32 v[84:85], v[40:41], v[90:91], v[86:87]
    ds_read_b64_tr_b16 v[126:127], v154 offset:0
    v_pk_fma_f32 v[86:87], v[84:85], v[74:75], v[84:85]
    ds_read_b64_tr_b16 v[130:131], v154 offset:64
    v_pk_fma_f32 v[90:91], v[88:89], v[74:75], v[88:89]
    ds_read_b32 v153, v152 offset:160
    v_pk_fma_f32 v[84:85], v[42:43], v[88:89], v[86:87]
    ds_read_b32 v232, v231 offset:128
    v_pk_fma_f32 v[86:87], v[84:85], v[76:77], v[84:85]
    v_pk_fma_f32 v[88:89], v[90:91], v[76:77], v[90:91]
    v_pk_fma_f32 v[84:85], v[44:45], v[90:91], v[86:87]
    v_pk_fma_f32 v[86:87], v[84:85], v[78:79], v[84:85]
    v_pk_fma_f32 v[90:91], v[88:89], v[78:79], v[88:89]
    v_pk_fma_f32 v[84:85], v[46:47], v[88:89], v[86:87]
    v_pk_fma_f32 v[86:87], v[84:85], v[80:81], v[84:85]
    v_pk_fma_f32 v[88:89], v[90:91], v[80:81], v[90:91]
    v_pk_fma_f32 v[84:85], v[48:49], v[90:91], v[86:87]
    v_pk_fma_f32 v[86:87], v[84:85], v[82:83], v[84:85]
    v_pk_fma_f32 v[90:91], v[88:89], v[82:83], v[88:89]
    v_rcp_f32 v92, v90
    v_rcp_f32 v93, v91
    v_pk_fma_f32 v[84:85], v[50:51], v[88:89], v[86:87]
    v_pk_mul_f32 v[84:85], v[84:85], v[92:93]
    v_cvt_pk_bf16_f32 v99, v84, v85
    s_setprio 0
    s_waitcnt vmcnt(4)
    ds_read_b64_tr_b16 v[36:37], v136 offset:0
    ds_read_b64_tr_b16 v[38:39], v136 offset:1040
    ds_read_b64_tr_b16 v[40:41], v136 offset:2080
    ds_read_b64_tr_b16 v[42:43], v136 offset:3120
    ds_read_b64_tr_b16 v[44:45], v138 offset:0
    ds_read_b64_tr_b16 v[46:47], v138 offset:1040
    ds_read_b64_tr_b16 v[48:49], v138 offset:2080
    ds_read_b64_tr_b16 v[50:51], v138 offset:3120
    v_mfma_f32_32x32x16_bf16 v[4:19], v[96:99], v[132:135], v[4:19]
    v_exp_f32 v68, v52
    v_exp_f32 v69, v53
    v_exp_f32 v70, v54
    v_exp_f32 v71, v55
    v_exp_f32 v72, v56
    v_exp_f32 v73, v57
    v_exp_f32 v74, v58
    v_exp_f32 v75, v59
    v_exp_f32 v76, v60
    s_waitcnt lgkmcnt(0)
    v_mfma_f32_32x32x16_bf16 v[36:51], v[120:123], v[124:127], v[36:51]
    v_exp_f32 v77, v61
    v_exp_f32 v78, v62
    v_exp_f32 v79, v63
    v_exp_f32 v80, v64
    v_exp_f32 v81, v65
    v_exp_f32 v82, v66
    v_exp_f32 v83, v67
    v_pk_add_f32 v[88:89], v[68:69], s[40:41]
    ds_read_b128 v[144:147], v151 offset:768
    v_pk_fma_f32 v[86:87], v[52:53], v[70:71], v[52:53]
    v_pk_fma_f32 v[90:91], v[88:89], v[70:71], v[88:89]
    v_pk_fma_f32 v[84:85], v[54:55], v[88:89], v[86:87]
    v_pk_fma_f32 v[86:87], v[84:85], v[72:73], v[84:85]
    v_pk_fma_f32 v[88:89], v[90:91], v[72:73], v[90:91]
    v_pk_fma_f32 v[84:85], v[56:57], v[90:91], v[86:87]
    v_pk_fma_f32 v[86:87], v[84:85], v[74:75], v[84:85]
    v_pk_fma_f32 v[90:91], v[88:89], v[74:75], v[88:89]
    v_pk_fma_f32 v[84:85], v[58:59], v[88:89], v[86:87]
    v_pk_fma_f32 v[86:87], v[84:85], v[76:77], v[84:85]
    v_pk_fma_f32 v[88:89], v[90:91], v[76:77], v[90:91]
    v_pk_fma_f32 v[84:85], v[60:61], v[90:91], v[86:87]
    v_pk_fma_f32 v[86:87], v[84:85], v[78:79], v[84:85]
    v_pk_fma_f32 v[90:91], v[88:89], v[78:79], v[88:89]
    v_pk_fma_f32 v[84:85], v[62:63], v[88:89], v[86:87]
    v_pk_fma_f32 v[86:87], v[84:85], v[80:81], v[84:85]
    v_lshl_add_u32 v149, v150, 1, v149
    v_pk_fma_f32 v[88:89], v[90:91], v[80:81], v[90:91]
    v_pk_fma_f32 v[84:85], v[64:65], v[90:91], v[86:87]
    v_add_u32 v151, 512, v151
    v_pk_fma_f32 v[86:87], v[84:85], v[82:83], v[84:85]
    v_pk_fma_f32 v[90:91], v[88:89], v[82:83], v[88:89]
    v_add_u32 v152, 128, v152
    v_rcp_f32 v92, v90
    v_rcp_f32 v93, v91
    v_add_u32 v231, 128, v231
    v_pk_fma_f32 v[84:85], v[66:67], v[88:89], v[86:87]
    v_pk_mul_f32 v[84:85], v[84:85], v[92:93]
    v_cvt_pk_bf16_f32 v103, v84, v85
    s_sub_u32 s81, s81, 1
    s_cmp_lg_u32 s81, 0
    s_cbranch_scc1 K_LOOP_8
    s_cmp_eq_u32 s46, 0
    s_cbranch_scc1 K_EXITB
K_LOOP_F:
    s_setprio 3
    ds_read_b64_tr_b16 v[52:53], v137 offset:0
    ds_read_b64_tr_b16 v[54:55], v137 offset:1040
    ds_read_b64_tr_b16 v[56:57], v137 offset:2080
    ds_read_b64_tr_b16 v[58:59], v137 offset:3120
    ds_read_b64_tr_b16 v[60:61], v139 offset:0
    ds_read_b64_tr_b16 v[62:63], v139 offset:1040
    ds_read_b64_tr_b16 v[64:65], v139 offset:2080
    ds_read_b64_tr_b16 v[66:67], v139 offset:3120
    v_mfma_f32_32x32x16_bf16 v[20:35], v[100:103], v[132:135], v[20:35]
    v_exp_f32 v68, v36
    v_exp_f32 v69, v37
    v_exp_f32 v70, v38
    v_exp_f32 v71, v39
    v_exp_f32 v72, v40
    v_exp_f32 v73, v41
    v_exp_f32 v74, v42
    v_exp_f32 v75, v43
    v_exp_f32 v76, v44
    s_waitcnt lgkmcnt(0)
    v_mfma_f32_32x32x16_bf16 v[52:67], v[120:123], v[128:131], v[52:67]
    v_exp_f32 v77, v45
    v_exp_f32 v78, v46
    v_exp_f32 v79, v47
    v_exp_f32 v80, v48
    v_exp_f32 v81, v49
    v_exp_f32 v82, v50
    v_exp_f32 v83, v51
    v_pk_add_f32 v[88:89], v[68:69], s[40:41]
    s_mov_b32 m0, s44
    v_add_u32 v155, v153, v156
    v_pk_add_f32 v[90:91], v[76:77], s[40:41]
    buffer_load_dwordx4 v144, s[48:51], 0 offen offset:0 sc1 lds
    v_pk_fma_f32 v[84:85], v[36:37], v[70:71], v[36:37]
    buffer_load_dwordx4 v145, s[48:51], 0 offen offset:1040 sc1 lds
    v_pk_fma_f32 v[86:87], v[44:45], v[78:79], v[44:45]
    buffer_load_dwordx4 v146, s[48:51], 0 offen offset:2080 sc1 lds
    v_pk_fma_f32 v[84:85], v[38:39], v[88:89], v[84:85]
    buffer_load_dwordx4 v147, s[48:51], 0 offen offset:3120 sc1 lds
    v_pk_fma_f32 v[86:87], v[46:47], v[90:91], v[86:87]
    ds_read_b128 v[120:123], v149 offset:512
    v_pk_fma_f32 v[88:89], v[88:89], v[70:71], v[88:89]
    ds_read_b64_tr_b16 v[126:127], v155 offset:0
    v_pk_fma_f32 v[90:91], v[90:91], v[78:79], v[90:91]
    ds_read_b64_tr_b16 v[130:131], v155 offset:64
    v_pk_fma_f32 v[84:85], v[84:85], v[72:73], v[84:85]
    ds_read_b32 v153, v152 offset:64
    v_pk_fma_f32 v[86:87], v[86:87], v[80:81], v[86:87]
    ds_read_b64_tr_b16 v[132:133], v154 offset:128
    v_pk_fma_f32 v[84:85], v[40:41], v[88:89], v[84:85]
    ds_read_b64_tr_b16 v[134:135], v155 offset:128
    v_pk_fma_f32 v[86:87], v[48:49], v[90:91], v[86:87]
    v_pk_fma_f32 v[88:89], v[88:89], v[72:73], v[88:89]
    v_pk_fma_f32 v[90:91], v[90:91], v[80:81], v[90:91]
    v_pk_fma_f32 v[84:85], v[84:85], v[74:75], v[84:85]
    v_pk_fma_f32 v[86:87], v[86:87], v[82:83], v[86:87]
    v_pk_fma_f32 v[84:85], v[42:43], v[88:89], v[84:85]
    v_pk_fma_f32 v[86:87], v[50:51], v[90:91], v[86:87]
    v_pk_fma_f32 v[88:89], v[88:89], v[74:75], v[88:89]
    v_pk_fma_f32 v[90:91], v[90:91], v[82:83], v[90:91]
    v_rcp_f32 v92, v88
    v_rcp_f32 v93, v89
    v_rcp_f32 v94, v90
    v_rcp_f32 v95, v91
    v_pk_mul_f32 v[84:85], v[84:85], v[92:93]
    v_pk_mul_f32 v[86:87], v[86:87], v[94:95]
    v_cvt_pk_bf16_f32 v96, v84, v85
    v_cvt_pk_bf16_f32 v97, v86, v87
    s_setprio 2
    s_waitcnt vmcnt(4)
    ds_read_b64_tr_b16 v[36:37], v136 offset:4160
    ds_read_b64_tr_b16 v[38:39], v136 offset:5200
    ds_read_b64_tr_b16 v[40:41], v136 offset:6240
    ds_read_b64_tr_b16 v[42:43], v136 offset:7280
    ds_read_b64_tr_b16 v[44:45], v138 offset:4160
    ds_read_b64_tr_b16 v[46:47], v138 offset:5200
    ds_read_b64_tr_b16 v[48:49], v138 offset:6240
    ds_read_b64_tr_b16 v[50:51], v138 offset:7280
    v_exp_f32 v68, v52
    v_exp_f32 v69, v53
    v_exp_f32 v70, v54
    v_exp_f32 v71, v55
    v_exp_f32 v72, v56
    v_exp_f32 v73, v57
    v_exp_f32 v74, v58
    v_exp_f32 v75, v59
    v_exp_f32 v76, v60
    s_waitcnt lgkmcnt(0)
    v_mfma_f32_32x32x16_bf16 v[36:51], v[120:123], v[124:127], v[36:51]
    v_exp_f32 v77, v61
    v_exp_f32 v78, v62
    v_exp_f32 v79, v63
    v_exp_f32 v80, v64
    v_exp_f32 v81, v65
    v_exp_f32 v82, v66
    v_exp_f32 v83, v67
    v_pk_add_f32 v[88:89], v[68:69], s[40:41]
    ds_read_b128 v[144:147], v151 offset:384
    v_pk_add_f32 v[90:91], v[76:77], s[40:41]
    v_pk_fma_f32 v[84:85], v[52:53], v[70:71], v[52:53]
    v_pk_fma_f32 v[86:87], v[60:61], v[78:79], v[60:61]
    v_pk_fma_f32 v[84:85], v[54:55], v[88:89], v[84:85]
    v_pk_fma_f32 v[86:87], v[62:63], v[90:91], v[86:87]
    v_pk_fma_f32 v[88:89], v[88:89], v[70:71], v[88:89]
    v_pk_fma_f32 v[90:91], v[90:91], v[78:79], v[90:91]
    v_pk_fma_f32 v[84:85], v[84:85], v[72:73], v[84:85]
    v_pk_fma_f32 v[86:87], v[86:87], v[80:81], v[86:87]
    v_pk_fma_f32 v[84:85], v[56:57], v[88:89], v[84:85]
    v_pk_fma_f32 v[86:87], v[64:65], v[90:91], v[86:87]
    v_pk_fma_f32 v[88:89], v[88:89], v[72:73], v[88:89]
    v_pk_fma_f32 v[90:91], v[90:91], v[80:81], v[90:91]
    v_pk_fma_f32 v[84:85], v[84:85], v[74:75], v[84:85]
    v_pk_fma_f32 v[86:87], v[86:87], v[82:83], v[86:87]
    v_pk_fma_f32 v[84:85], v[58:59], v[88:89], v[84:85]
    v_pk_fma_f32 v[86:87], v[66:67], v[90:91], v[86:87]
    v_pk_fma_f32 v[88:89], v[88:89], v[74:75], v[88:89]
    v_pk_fma_f32 v[90:91], v[90:91], v[82:83], v[90:91]
    v_rcp_f32 v92, v88
    v_rcp_f32 v93, v89
    v_rcp_f32 v94, v90
    v_rcp_f32 v95, v91
    v_pk_mul_f32 v[84:85], v[84:85], v[92:93]
    v_pk_mul_f32 v[86:87], v[86:87], v[94:95]
    v_cvt_pk_bf16_f32 v100, v84, v85
    v_cvt_pk_bf16_f32 v101, v86, v87
    s_sub_u32 s46, s46, 1
    s_cmp_eq_u32 s46, 0
    s_cbranch_scc1 K_EXITA
    s_setprio 1
    ds_read_b64_tr_b16 v[52:53], v137 offset:4160
    ds_read_b64_tr_b16 v[54:55], v137 offset:5200
    ds_read_b64_tr_b16 v[56:57], v137 offset:6240
    ds_read_b64_tr_b16 v[58:59], v137 offset:7280
    ds_read_b64_tr_b16 v[60:61], v139 offset:4160
    ds_read_b64_tr_b16 v[62:63], v139 offset:5200
    ds_read_b64_tr_b16 v[64:65], v139 offset:6240
    ds_read_b64_tr_b16 v[66:67], v139 offset:7280
    v_exp_f32 v68, v36
    v_exp_f32 v69, v37
    v_exp_f32 v70, v38
    v_exp_f32 v71, v39
    v_exp_f32 v72, v40
    v_exp_f32 v73, v41
    v_exp_f32 v74, v42
    v_exp_f32 v75, v43
    v_exp_f32 v76, v44
    s_waitcnt lgkmcnt(0)
    v_mfma_f32_32x32x16_bf16 v[52:67], v[120:123], v[128:131], v[52:67]
    v_exp_f32 v77, v45
    v_exp_f32 v78, v46
    v_exp_f32 v79, v47
    v_exp_f32 v80, v48
    v_exp_f32 v81, v49
    v_exp_f32 v82, v50
    v_exp_f32 v83, v51
    v_pk_add_f32 v[88:89], v[68:69], s[40:41]
    s_mov_b32 m0, s45
    v_add_u32 v154, v153, v156
    v_pk_add_f32 v[90:91], v[76:77], s[40:41]
    buffer_load_dwordx4 v144, s[48:51], 0 offen offset:0 sc1 lds
    v_pk_fma_f32 v[84:85], v[36:37], v[70:71], v[36:37]
    buffer_load_dwordx4 v145, s[48:51], 0 offen offset:1040 sc1 lds
    v_pk_fma_f32 v[86:87], v[44:45], v[78:79], v[44:45]
    buffer_load_dwordx4 v146, s[48:51], 0 offen offset:2080 sc1 lds
    v_pk_fma_f32 v[84:85], v[38:39], v[88:89], v[84:85]
    buffer_load_dwordx4 v147, s[48:51], 0 offen offset:3120 sc1 lds
    v_pk_fma_f32 v[86:87], v[46:47], v[90:91], v[86:87]
    ds_read_b128 v[120:123], v149 offset:1024
    v_pk_fma_f32 v[88:89], v[88:89], v[70:71], v[88:89]
    ds_read_b64_tr_b16 v[126:127], v154 offset:0
    v_pk_fma_f32 v[90:91], v[90:91], v[78:79], v[90:91]
    ds_read_b64_tr_b16 v[130:131], v154 offset:64
    v_pk_fma_f32 v[84:85], v[84:85], v[72:73], v[84:85]
    ds_read_b32 v153, v152 offset:96
    v_pk_fma_f32 v[86:87], v[86:87], v[80:81], v[86:87]
    v_pk_fma_f32 v[84:85], v[40:41], v[88:89], v[84:85]
    v_pk_fma_f32 v[86:87], v[48:49], v[90:91], v[86:87]
    v_pk_fma_f32 v[88:89], v[88:89], v[72:73], v[88:89]
    v_pk_fma_f32 v[90:91], v[90:91], v[80:81], v[90:91]
    v_pk_fma_f32 v[84:85], v[84:85], v[74:75], v[84:85]
    v_pk_fma_f32 v[86:87], v[86:87], v[82:83], v[86:87]
    v_pk_fma_f32 v[84:85], v[42:43], v[88:89], v[84:85]
    v_pk_fma_f32 v[86:87], v[50:51], v[90:91], v[86:87]
    v_pk_fma_f32 v[88:89], v[88:89], v[74:75], v[88:89]
    v_pk_fma_f32 v[90:91], v[90:91], v[82:83], v[90:91]
    v_rcp_f32 v92, v88
    v_rcp_f32 v93, v89
    v_rcp_f32 v94, v90
    v_rcp_f32 v95, v91
    v_pk_mul_f32 v[84:85], v[84:85], v[92:93]
    v_pk_mul_f32 v[86:87], v[86:87], v[94:95]
    v_cvt_pk_bf16_f32 v98, v84, v85
    v_cvt_pk_bf16_f32 v99, v86, v87
    s_setprio 0
    s_waitcnt vmcnt(4)
    ds_read_b64_tr_b16 v[36:37], v136 offset:0
    ds_read_b64_tr_b16 v[38:39], v136 offset:1040
    ds_read_b64_tr_b16 v[40:41], v136 offset:2080
    ds_read_b64_tr_b16 v[42:43], v136 offset:3120
    ds_read_b64_tr_b16 v[44:45], v138 offset:0
    ds_read_b64_tr_b16 v[46:47], v138 offset:1040
    ds_read_b64_tr_b16 v[48:49], v138 offset:2080
    ds_read_b64_tr_b16 v[50:51], v138 offset:3120
    v_mfma_f32_32x32x16_bf16 v[4:19], v[96:99], v[132:135], v[4:19]
    v_exp_f32 v68, v52
    v_exp_f32 v69, v53
    v_exp_f32 v70, v54
    v_exp_f32 v71, v55
    v_exp_f32 v72, v56
    v_exp_f32 v73, v57
    v_exp_f32 v74, v58
    v_exp_f32 v75, v59
    v_exp_f32 v76, v60
    s_waitcnt lgkmcnt(0)
    v_mfma_f32_32x32x16_bf16 v[36:51], v[120:123], v[124:127], v[36:51]
    v_exp_f32 v77, v61
    v_exp_f32 v78, v62
    v_exp_f32 v79, v63
    v_exp_f32 v80, v64
    v_exp_f32 v81, v65
    v_exp_f32 v82, v66
    v_exp_f32 v83, v67
    v_pk_add_f32 v[88:89], v[68:69], s[40:41]
    ds_read_b128 v[144:147], v151 offset:512
    v_pk_add_f32 v[90:91], v[76:77], s[40:41]
    v_pk_fma_f32 v[84:85], v[52:53], v[70:71], v[52:53]
    v_pk_fma_f32 v[86:87], v[60:61], v[78:79], v[60:61]
    v_pk_fma_f32 v[84:85], v[54:55], v[88:89], v[84:85]
    v_pk_fma_f32 v[86:87], v[62:63], v[90:91], v[86:87]
    v_pk_fma_f32 v[88:89], v[88:89], v[70:71], v[88:89]
    v_pk_fma_f32 v[90:91], v[90:91], v[78:79], v[90:91]
    v_pk_fma_f32 v[84:85], v[84:85], v[72:73], v[84:85]
    v_pk_fma_f32 v[86:87], v[86:87], v[80:81], v[86:87]
    v_pk_fma_f32 v[84:85], v[56:57], v[88:89], v[84:85]
    v_pk_fma_f32 v[86:87], v[64:65], v[90:91], v[86:87]
    v_pk_fma_f32 v[88:89], v[88:89], v[72:73], v[88:89]
    v_pk_fma_f32 v[90:91], v[90:91], v[80:81], v[90:91]
    v_pk_fma_f32 v[84:85], v[84:85], v[74:75], v[84:85]
    v_pk_fma_f32 v[86:87], v[86:87], v[82:83], v[86:87]
    v_pk_fma_f32 v[84:85], v[58:59], v[88:89], v[84:85]
    v_pk_fma_f32 v[86:87], v[66:67], v[90:91], v[86:87]
    v_pk_fma_f32 v[88:89], v[88:89], v[74:75], v[88:89]
    v_add_u32 v149, v150, v149
    v_pk_fma_f32 v[90:91], v[90:91], v[82:83], v[90:91]
    v_rcp_f32 v92, v88
    v_add_u32 v151, 256, v151
    v_rcp_f32 v93, v89
    v_rcp_f32 v94, v90
    v_add_u32 v152, 64, v152
    v_rcp_f32 v95, v91
    v_pk_mul_f32 v[84:85], v[84:85], v[92:93]
    v_pk_mul_f32 v[86:87], v[86:87], v[94:95]
    v_cvt_pk_bf16_f32 v102, v84, v85
    v_cvt_pk_bf16_f32 v103, v86, v87
    s_sub_u32 s46, s46, 1
    s_cmp_lg_u32 s46, 0
    s_cbranch_scc1 K_LOOP_F
    s_branch K_EXITB
K_LOOP_S:
    s_setprio 3
    ds_read_b64_tr_b16 v[52:53], v137 offset:0
    ds_read_b64_tr_b16 v[54:55], v137 offset:1040
    ds_read_b64_tr_b16 v[56:57], v137 offset:2080
    ds_read_b64_tr_b16 v[58:59], v137 offset:3120
    ds_read_b64_tr_b16 v[60:61], v139 offset:0
    ds_read_b64_tr_b16 v[62:63], v139 offset:1040
    ds_read_b64_tr_b16 v[64:65], v139 offset:2080
    ds_read_b64_tr_b16 v[66:67], v139 offset:3120
    v_mfma_f32_32x32x16_bf16 v[20:35], v[100:103], v[132:135], v[20:35]
    v_exp_f32 v68, v36
    v_exp_f32 v69, v37
    v_exp_f32 v70, v38
    v_exp_f32 v71, v39
    v_exp_f32 v72, v40
    v_exp_f32 v73, v41
    v_exp_f32 v74, v42
    v_exp_f32 v75, v43
    v_exp_f32 v76, v44
    s_waitcnt lgkmcnt(0)
    v_mfma_f32_32x32x16_bf16 v[52:67], v[120:123], v[128:131], v[52:67]
    v_exp_f32 v77, v45
    v_exp_f32 v78, v46
    v_exp_f32 v79, v47
    v_exp_f32 v80, v48
    v_exp_f32 v81, v49
    v_exp_f32 v82, v50
    v_exp_f32 v83, v51
    v_pk_add_f32 v[68:69], v[68:69], s[40:41]
    s_mov_b32 m0, s44
    v_add_u32 v155, v153, v156
    v_pk_add_f32 v[70:71], v[70:71], s[40:41]
    buffer_load_dwordx4 v144, s[48:51], 0 offen offset:0 sc1 lds
    v_pk_add_f32 v[72:73], v[72:73], s[40:41]
    buffer_load_dwordx4 v145, s[48:51], 0 offen offset:1040 sc1 lds
    v_pk_add_f32 v[74:75], v[74:75], s[40:41]
    buffer_load_dwordx4 v146, s[48:51], 0 offen offset:2080 sc1 lds
    v_pk_add_f32 v[76:77], v[76:77], s[40:41]
    buffer_load_dwordx4 v147, s[48:51], 0 offen offset:3120 sc1 lds
    v_pk_add_f32 v[78:79], v[78:79], s[40:41]
    ds_read_b128 v[120:123], v149 offset:512
    v_pk_add_f32 v[80:81], v[80:81], s[40:41]
    ds_read_b64_tr_b16 v[126:127], v155 offset:0
    v_pk_add_f32 v[82:83], v[82:83], s[40:41]
    ds_read_b64_tr_b16 v[130:131], v155 offset:64
    v_rcp_f32 v68, v68
    ds_read_b32 v153, v152 offset:64
    v_rcp_f32 v69, v69
    ds_read_b64_tr_b16 v[132:133], v154 offset:128
    v_rcp_f32 v70, v70
    ds_read_b64_tr_b16 v[134:135], v155 offset:128
    v_rcp_f32 v71, v71
    v_rcp_f32 v72, v72
    v_rcp_f32 v73, v73
    v_rcp_f32 v74, v74
    v_rcp_f32 v75, v75
    v_rcp_f32 v76, v76
    v_rcp_f32 v77, v77
    v_rcp_f32 v78, v78
    v_rcp_f32 v79, v79
    v_rcp_f32 v80, v80
    v_rcp_f32 v81, v81
    v_rcp_f32 v82, v82
    v_rcp_f32 v83, v83
    v_pk_mul_f32 v[84:85], v[36:37], v[68:69]
    v_pk_mul_f32 v[86:87], v[44:45], v[76:77]
    v_pk_fma_f32 v[84:85], v[38:39], v[70:71], v[84:85]
    v_pk_fma_f32 v[86:87], v[46:47], v[78:79], v[86:87]
    v_pk_fma_f32 v[84:85], v[40:41], v[72:73], v[84:85]
    v_pk_fma_f32 v[86:87], v[48:49], v[80:81], v[86:87]
    v_pk_fma_f32 v[84:85], v[42:43], v[74:75], v[84:85]
    v_pk_fma_f32 v[86:87], v[50:51], v[82:83], v[86:87]
    v_cvt_pk_bf16_f32 v96, v84, v85
    v_cvt_pk_bf16_f32 v97, v86, v87
    s_setprio 2
    s_waitcnt vmcnt(4)
    ds_read_b64_tr_b16 v[36:37], v136 offset:4160
    ds_read_b64_tr_b16 v[38:39], v136 offset:5200
    ds_read_b64_tr_b16 v[40:41], v136 offset:6240
    ds_read_b64_tr_b16 v[42:43], v136 offset:7280
    ds_read_b64_tr_b16 v[44:45], v138 offset:4160
    ds_read_b64_tr_b16 v[46:47], v138 offset:5200
    ds_read_b64_tr_b16 v[48:49], v138 offset:6240
    ds_read_b64_tr_b16 v[50:51], v138 offset:7280
    v_exp_f32 v68, v52
    v_exp_f32 v69, v53
    v_exp_f32 v70, v54
    v_exp_f32 v71, v55
    v_exp_f32 v72, v56
    v_exp_f32 v73, v57
    v_exp_f32 v74, v58
    v_exp_f32 v75, v59
    v_exp_f32 v76, v60
    s_waitcnt lgkmcnt(0)
    v_mfma_f32_32x32x16_bf16 v[36:51], v[120:123], v[124:127], v[36:51]
    v_exp_f32 v77, v61
    v_exp_f32 v78, v62
    v_exp_f32 v79, v63
    v_exp_f32 v80, v64
    v_exp_f32 v81, v65
    v_exp_f32 v82, v66
    v_exp_f32 v83, v67
    v_pk_add_f32 v[68:69], v[68:69], s[40:41]
    ds_read_b128 v[144:147], v151 offset:384
    v_pk_add_f32 v[70:71], v[70:71], s[40:41]
    v_pk_add_f32 v[72:73], v[72:73], s[40:41]
    v_pk_add_f32 v[74:75], v[74:75], s[40:41]
    v_pk_add_f32 v[76:77], v[76:77], s[40:41]
    v_pk_add_f32 v[78:79], v[78:79], s[40:41]
    v_pk_add_f32 v[80:81], v[80:81], s[40:41]
    v_pk_add_f32 v[82:83], v[82:83], s[40:41]
    v_rcp_f32 v68, v68
    v_rcp_f32 v69, v69
    v_rcp_f32 v70, v70
    v_rcp_f32 v71, v71
    v_rcp_f32 v72, v72
    v_rcp_f32 v73, v73
    v_rcp_f32 v74, v74
    v_rcp_f32 v75, v75
    v_rcp_f32 v76, v76
    v_rcp_f32 v77, v77
    v_rcp_f32 v78, v78
    v_rcp_f32 v79, v79
    v_rcp_f32 v80, v80
    v_rcp_f32 v81, v81
    v_rcp_f32 v82, v82
    v_rcp_f32 v83, v83
    v_pk_mul_f32 v[84:85], v[52:53], v[68:69]
    v_pk_mul_f32 v[86:87], v[60:61], v[76:77]
    v_pk_fma_f32 v[84:85], v[54:55], v[70:71], v[84:85]
    v_pk_fma_f32 v[86:87], v[62:63], v[78:79], v[86:87]
    v_pk_fma_f32 v[84:85], v[56:57], v[72:73], v[84:85]
    v_pk_fma_f32 v[86:87], v[64:65], v[80:81], v[86:87]
    v_pk_fma_f32 v[84:85], v[58:59], v[74:75], v[84:85]
    v_pk_fma_f32 v[86:87], v[66:67], v[82:83], v[86:87]
    v_cvt_pk_bf16_f32 v100, v84, v85
    v_cvt_pk_bf16_f32 v101, v86, v87
    s_sub_u32 s46, s46, 1
    s_cmp_eq_u32 s46, 0
    s_cbranch_scc1 K_EXITA
    s_setprio 1
    ds_read_b64_tr_b16 v[52:53], v137 offset:4160
    ds_read_b64_tr_b16 v[54:55], v137 offset:5200
    ds_read_b64_tr_b16 v[56:57], v137 offset:6240
    ds_read_b64_tr_b16 v[58:59], v137 offset:7280
    ds_read_b64_tr_b16 v[60:61], v139 offset:4160
    ds_read_b64_tr_b16 v[62:63], v139 offset:5200
    ds_read_b64_tr_b16 v[64:65], v139 offset:6240
    ds_read_b64_tr_b16 v[66:67], v139 offset:7280
    v_exp_f32 v68, v36
    v_exp_f32 v69, v37
    v_exp_f32 v70, v38
    v_exp_f32 v71, v39
    v_exp_f32 v72, v40
    v_exp_f32 v73, v41
    v_exp_f32 v74, v42
    v_exp_f32 v75, v43
    v_exp_f32 v76, v44
    s_waitcnt lgkmcnt(0)
    v_mfma_f32_32x32x16_bf16 v[52:67], v[120:123], v[128:131], v[52:67]
    v_exp_f32 v77, v45
    v_exp_f32 v78, v46
    v_exp_f32 v79, v47
    v_exp_f32 v80, v48
    v_exp_f32 v81, v49
    v_exp_f32 v82, v50
    v_exp_f32 v83, v51
    v_pk_add_f32 v[68:69], v[68:69], s[40:41]
    s_mov_b32 m0, s45
    v_add_u32 v154, v153, v156
    v_pk_add_f32 v[70:71], v[70:71], s[40:41]
    buffer_load_dwordx4 v144, s[48:51], 0 offen offset:0 sc1 lds
    v_pk_add_f32 v[72:73], v[72:73], s[40:41]
    buffer_load_dwordx4 v145, s[48:51], 0 offen offset:1040 sc1 lds
    v_pk_add_f32 v[74:75], v[74:75], s[40:41]
    buffer_load_dwordx4 v146, s[48:51], 0 offen offset:2080 sc1 lds
    v_pk_add_f32 v[76:77], v[76:77], s[40:41]
    buffer_load_dwordx4 v147, s[48:51], 0 offen offset:3120 sc1 lds
    v_pk_add_f32 v[78:79], v[78:79], s[40:41]
    ds_read_b128 v[120:123], v149 offset:1024
    v_pk_add_f32 v[80:81], v[80:81], s[40:41]
    ds_read_b64_tr_b16 v[126:127], v154 offset:0
    v_pk_add_f32 v[82:83], v[82:83], s[40:41]
    ds_read_b64_tr_b16 v[130:131], v154 offset:64
    v_rcp_f32 v68, v68
    ds_read_b32 v153, v152 offset:96
    v_rcp_f32 v69, v69
    v_rcp_f32 v70, v70
    v_rcp_f32 v71, v71
    v_rcp_f32 v72, v72
    v_rcp_f32 v73, v73
    v_rcp_f32 v74, v74
    v_rcp_f32 v75, v75
    v_rcp_f32 v76, v76
    v_rcp_f32 v77, v77
    v_rcp_f32 v78, v78
    v_rcp_f32 v79, v79
    v_rcp_f32 v80, v80
    v_rcp_f32 v81, v81
    v_rcp_f32 v82, v82
    v_rcp_f32 v83, v83
    v_pk_mul_f32 v[84:85], v[36:37], v[68:69]
    v_pk_mul_f32 v[86:87], v[44:45], v[76:77]
    v_pk_fma_f32 v[84:85], v[38:39], v[70:71], v[84:85]
    v_pk_fma_f32 v[86:87], v[46:47], v[78:79], v[86:87]
    v_pk_fma_f32 v[84:85], v[40:41], v[72:73], v[84:85]
    v_pk_fma_f32 v[86:87], v[48:49], v[80:81], v[86:87]
    v_pk_fma_f32 v[84:85], v[42:43], v[74:75], v[84:85]
    v_pk_fma_f32 v[86:87], v[50:51], v[82:83], v[86:87]
    v_cvt_pk_bf16_f32 v98, v84, v85
    v_cvt_pk_bf16_f32 v99, v86, v87
    s_setprio 0
    s_waitcnt vmcnt(4)
    ds_read_b64_tr_b16 v[36:37], v136 offset:0
    ds_read_b64_tr_b16 v[38:39], v136 offset:1040
    ds_read_b64_tr_b16 v[40:41], v136 offset:2080
    ds_read_b64_tr_b16 v[42:43], v136 offset:3120
    ds_read_b64_tr_b16 v[44:45], v138 offset:0
    ds_read_b64_tr_b16 v[46:47], v138 offset:1040
    ds_read_b64_tr_b16 v[48:49], v138 offset:2080
    ds_read_b64_tr_b16 v[50:51], v138 offset:3120
    v_mfma_f32_32x32x16_bf16 v[4:19], v[96:99], v[132:135], v[4:19]
    v_exp_f32 v68, v52
    v_exp_f32 v69, v53
    v_exp_f32 v70, v54
    v_exp_f32 v71, v55
    v_exp_f32 v72, v56
    v_exp_f32 v73, v57
    v_exp_f32 v74, v58
    v_exp_f32 v75, v59
    v_exp_f32 v76, v60
    s_waitcnt lgkmcnt(0)
    v_mfma_f32_32x32x16_bf16 v[36:51], v[120:123], v[124:127], v[36:51]
    v_exp_f32 v77, v61
    v_exp_f32 v78, v62
    v_exp_f32 v79, v63
    v_exp_f32 v80, v64
    v_exp_f32 v81, v65
    v_exp_f32 v82, v66
    v_exp_f32 v83, v67
    v_pk_add_f32 v[68:69], v[68:69], s[40:41]
    ds_read_b128 v[144:147], v151 offset:512
    v_pk_add_f32 v[70:71], v[70:71], s[40:41]
    v_pk_add_f32 v[72:73], v[72:73], s[40:41]
    v_pk_add_f32 v[74:75], v[74:75], s[40:41]
    v_pk_add_f32 v[76:77], v[76:77], s[40:41]
    v_pk_add_f32 v[78:79], v[78:79], s[40:41]
    v_pk_add_f32 v[80:81], v[80:81], s[40:41]
    v_pk_add_f32 v[82:83], v[82:83], s[40:41]
    v_rcp_f32 v68, v68
    v_rcp_f32 v69, v69
    v_rcp_f32 v70, v70
    v_rcp_f32 v71, v71
    v_rcp_f32 v72, v72
    v_rcp_f32 v73, v73
    v_rcp_f32 v74, v74
    v_rcp_f32 v75, v75
    v_rcp_f32 v76, v76
    v_rcp_f32 v77, v77
    v_rcp_f32 v78, v78
    v_rcp_f32 v79, v79
    v_rcp_f32 v80, v80
    v_rcp_f32 v81, v81
    v_rcp_f32 v82, v82
    v_rcp_f32 v83, v83
    v_pk_mul_f32 v[84:85], v[52:53], v[68:69]
    v_add_u32 v149, v150, v149
    v_pk_mul_f32 v[86:87], v[60:61], v[76:77]
    v_pk_fma_f32 v[84:85], v[54:55], v[70:71], v[84:85]
    v_add_u32 v151, 256, v151
    v_pk_fma_f32 v[86:87], v[62:63], v[78:79], v[86:87]
    v_pk_fma_f32 v[84:85], v[56:57], v[72:73], v[84:85]
    v_add_u32 v152, 64, v152
    v_pk_fma_f32 v[86:87], v[64:65], v[80:81], v[86:87]
    v_pk_fma_f32 v[84:85], v[58:59], v[74:75], v[84:85]
    v_pk_fma_f32 v[86:87], v[66:67], v[82:83], v[86:87]
    v_cvt_pk_bf16_f32 v102, v84, v85
    v_cvt_pk_bf16_f32 v103, v86, v87
    s_sub_u32 s46, s46, 1
    s_cmp_lg_u32 s46, 0
    s_cbranch_scc1 K_LOOP_S
    s_branch K_EXITB
K_EXITA:
    v_mov_b32 v134, 0
    v_mov_b32 v135, 0
    s_nop 1
    v_mfma_f32_32x32x16_bf16 v[4:19], v[96:99], v[132:135], v[4:19]
K_EXITB:
    s_nop 1
    v_mfma_f32_32x32x16_bf16 v[20:35], v[100:103], v[132:135], v[20:35]
K_DONE:
    s_setprio 0
    s_add_u32 s29, s29, 1
    s_add_u32 s31, s31, 256
    s_cmp_lt_u32 s29, s47
    s_waitcnt vmcnt(0) lgkmcnt(0)
    s_cbranch_scc0 K_EPI
    s_nop 7
    s_barrier
    v_mov_b32 v104, 0x3f80
    v_mov_b32 v105, 0
    v_bfe_u32 v106, v0, 2, 2
    v_mul_u32_u24 v106, 40, v106
    v_and_b32 v106, 48, v106
    v_lshlrev_b64 v[106:107], v106, v[104:105]
    v_mov_b32 v104, 0
    ds_write_b128 v2, v[104:107] offset:14880
    ds_write_b128 v2, v[104:107] offset:23072
    ds_write_b128 v2, v[104:107] offset:31264
    ds_write_b128 v2, v[104:107] offset:39456
    ds_write_b128 v2, v[104:107] offset:47648
    v_mov_b32 v106, 0
    v_mov_b32 v107, 0
    v_lshlrev_b32 v69, 2, v1
    ds_write_b32 v69, v104 offset:12816
    v_bfe_u32 v69, v0, 0, 2
    v_mul_u32_u24 v69, 5, v69
    v_bfe_u32 v69, v69, 1, 2
    v_and_or_b32 v69, v0, 4, v69
    v_lshlrev_b32 v69, 7, v69
    v_sub_u32 v108, 6404096, v69
    v_subrev_u32 v109, 1040, v108
    v_subrev_u32 v110, 2080, v108
    v_subrev_u32 v111, 3120, v108
    ds_write_b128 v2, v[108:111] offset:2560
    v_and_b32 v69, 127, v0
    v_lshlrev_b32 v70, 4, v69
    ds_write_b128 v70, v[108:111] offset:10752
    v_mov_b32 v71, 9408
    v_lshlrev_b32 v70, 2, v0
    ds_write_b32 v70, v71 offset:0
    v_lshlrev_b32 v69, 2, v69
    ds_write_b32 v69, v71 offset:2048
    v_and_b32 v69, 1, v1
    v_lshrrev_b32 v72, 1, v0
    v_mul_u32_u24 v72, 1600, v72
    v_sub_u32 v83, 1, v69
    v_add_u32 v78, s31, v1
    v_mul_u32_u24 v78, 12, v78
    v_add_u32 v79, 768, v78
    v_add_u32 v80, 1536, v78
    v_add_u32 v81, 2304, v78
    s_mov_b32 s87, s44
    v_lshl_add_u32 v82, v1, 2, s87
    s_lshl_b32 s88, s31, 2
    s_sub_u32 s88, s87, s88
    s_add_u32 s87, s31, 256
    s_branch K_POLLD
K_EPI:
    v_and_b32 v76, 31, v1
    v_lshrrev_b32 v77, 5, v1
    s_lshl_b32 s88, s25, 5
    v_add_u32 v78, s88, v76
    v_mul_u32_u24 v68, 528, v78
    s_lshl_b32 s88, s26, 7
    v_lshl_add_u32 v69, v77, 5, s88
    v_add_u32 v69, v69, v68
    v_lshl_add_u32 v68, v77, 4, v68
    s_mul_i32 s88, s26, 16640
    s_add_u32 s88, s88, 94240
    v_lshl_add_u32 v70, v1, 4, s88
    v_cvt_pk_bf16_f32 v36, v4, v5
    v_cvt_pk_bf16_f32 v37, v6, v7
    v_cvt_pk_bf16_f32 v38, v8, v9
    v_cvt_pk_bf16_f32 v39, v10, v11
    v_cvt_pk_bf16_f32 v40, v12, v13
    v_cvt_pk_bf16_f32 v41, v14, v15
    v_cvt_pk_bf16_f32 v42, v16, v17
    v_cvt_pk_bf16_f32 v43, v18, v19
    v_cvt_pk_bf16_f32 v44, v20, v21
    v_cvt_pk_bf16_f32 v45, v22, v23
    v_cvt_pk_bf16_f32 v46, v24, v25
    v_cvt_pk_bf16_f32 v47, v26, v27
    v_cvt_pk_bf16_f32 v48, v28, v29
    v_cvt_pk_bf16_f32 v49, v30, v31
    v_cvt_pk_bf16_f32 v50, v32, v33
    v_cvt_pk_bf16_f32 v51, v34, v35
    s_barrier
    ds_write_b128 v69, v[36:39] offset:14880
    ds_write_b128 v69, v[40:43] offset:14896
    ds_write_b128 v69, v[44:47] offset:14944
    ds_write_b128 v69, v[48:51] offset:14960
    ds_read_b128 v[160:163], v70 offset:0
    ds_read_b128 v[164:167], v70 offset:1040
    ds_read_b128 v[168:171], v70 offset:2080
    ds_read_b128 v[172:175], v70 offset:3120
    ds_read_b128 v[176:179], v70 offset:4160
    ds_read_b128 v[180:183], v70 offset:5200
    s_mul_i32 s88, s25, 100
    v_lshl_add_u32 v79, v76, 2, s88
    ds_bpermute_b32 v79, v79, v158
    s_lshl_b32 s88, s26, 6
    v_lshl_add_u32 v80, v77, 3, s88
    ds_read_b64 v[52:53], v80 offset:13840
    ds_read_b64 v[54:55], v80 offset:13856
    ds_read_b64 v[56:57], v80 offset:13872
    ds_read_b64 v[58:59], v80 offset:13888
    s_waitcnt lgkmcnt(11)
    s_barrier
    ds_read_b128 v[4:7], v68 offset:14880
    ds_read_b128 v[8:11], v68 offset:14912
    ds_read_b128 v[12:15], v68 offset:14944
    ds_read_b128 v[16:19], v68 offset:14976
    s_waitcnt lgkmcnt(3)
    v_mfma_f32_32x32x16_bf16 v[240:255], v[160:163], v[4:7], 0
    ds_read_b128 v[20:23], v68 offset:15008
    ds_read_b128 v[184:187], v70 offset:6240
    v_cvt_f32_u32 v79, v79
    v_lshlrev_b32 v224, 16, v52
    v_and_b32 v225, 0xffff0000, v52
    v_lshlrev_b32 v226, 16, v53
    s_waitcnt lgkmcnt(4)
    v_mfma_f32_32x32x16_bf16 v[240:255], v[164:167], v[8:11], v[240:255]
    ds_read_b128 v[24:27], v68 offset:15040
    ds_read_b128 v[188:191], v70 offset:7280
    v_and_b32 v227, 0xffff0000, v53
    v_lshlrev_b32 v228, 16, v54
    v_and_b32 v229, 0xffff0000, v54
    v_lshlrev_b32 v230, 16, v55
    s_waitcnt lgkmcnt(5)
    v_mfma_f32_32x32x16_bf16 v[240:255], v[168:171], v[12:15], v[240:255]
    ds_read_b128 v[28:31], v68 offset:15072
    ds_read_b128 v[192:195], v70 offset:8320
    v_and_b32 v231, 0xffff0000, v55
    v_lshlrev_b32 v232, 16, v56
    v_and_b32 v233, 0xffff0000, v56
    v_lshlrev_b32 v234, 16, v57
    s_waitcnt lgkmcnt(6)
    v_mfma_f32_32x32x16_bf16 v[240:255], v[172:175], v[16:19], v[240:255]
    ds_read_b128 v[32:35], v68 offset:15104
    ds_read_b128 v[196:199], v70 offset:9360
    v_and_b32 v235, 0xffff0000, v57
    v_lshlrev_b32 v236, 16, v58
    v_and_b32 v237, 0xffff0000, v58
    v_lshlrev_b32 v238, 16, v59
    s_waitcnt lgkmcnt(7)
    v_mfma_f32_32x32x16_bf16 v[240:255], v[176:179], v[20:23], v[240:255]
    ds_read_b128 v[104:107], v68 offset:15136
    ds_read_b128 v[200:203], v70 offset:10400
    v_and_b32 v239, 0xffff0000, v59
    v_mul_f32 v224, v79, v224
    v_mul_f32 v225, v79, v225
    v_mul_f32 v226, v79, v226
    s_waitcnt lgkmcnt(7)
    v_mfma_f32_32x32x16_bf16 v[240:255], v[180:183], v[24:27], v[240:255]
    ds_read_b128 v[108:111], v68 offset:15168
    ds_read_b128 v[204:207], v70 offset:11440
    v_mul_f32 v227, v79, v227
    v_mul_f32 v228, v79, v228
    v_mul_f32 v229, v79, v229
    v_mul_f32 v230, v79, v230
    s_waitcnt lgkmcnt(7)
    v_mfma_f32_32x32x16_bf16 v[240:255], v[184:187], v[28:31], v[240:255]
    ds_read_b128 v[112:115], v68 offset:15200
    ds_read_b128 v[208:211], v70 offset:12480
    v_mul_f32 v231, v79, v231
    v_mul_f32 v232, v79, v232
    v_mul_f32 v233, v79, v233
    v_mul_f32 v234, v79, v234
    s_waitcnt lgkmcnt(7)
    v_mfma_f32_32x32x16_bf16 v[240:255], v[188:191], v[32:35], v[240:255]
    ds_read_b128 v[116:119], v68 offset:15232
    ds_read_b128 v[212:215], v70 offset:13520
    v_mul_f32 v235, v79, v235
    v_mul_f32 v236, v79, v236
    v_mul_f32 v237, v79, v237
    v_mul_f32 v238, v79, v238
    s_waitcnt lgkmcnt(7)
    v_mfma_f32_32x32x16_bf16 v[240:255], v[192:195], v[104:107], v[240:255]
    ds_read_b128 v[84:87], v68 offset:15264
    ds_read_b128 v[216:219], v70 offset:14560
    v_mul_f32 v239, v79, v239
    v_mul_u32_u24 v71, 272, v78
    v_add_u32 v71, v71, v80
    v_add_u32 v71, 55840, v71
    s_waitcnt lgkmcnt(7)
    v_mfma_f32_32x32x16_bf16 v[240:255], v[196:199], v[108:111], v[240:255]
    ds_read_b128 v[88:91], v68 offset:15296
    ds_read_b128 v[220:223], v70 offset:15600
    s_movk_i32 s89, 272
    v_lshrrev_b32 v81, 4, v0
    v_and_b32 v82, 15, v0
    v_lshlrev_b32 v82, 4, v82
    s_waitcnt lgkmcnt(7)
    v_mfma_f32_32x32x16_bf16 v[240:255], v[200:203], v[112:115], v[240:255]
    ds_read_b128 v[92:95], v68 offset:15328
    v_lshl_add_u32 v73, v81, 8, v82
    v_cmp_lt_u32 vcc, 24, v81
    v_mov_b32 v83, 7
    v_add_u32 v82, 55840, v82
    s_waitcnt lgkmcnt(6)
    v_mfma_f32_32x32x16_bf16 v[240:255], v[204:207], v[116:119], v[240:255]
    ds_read_b128 v[96:99], v68 offset:15360
    v_cndmask_b32 v83, 0, v83, vcc
    v_add_u32 v83, v83, v81
    v_mad_u32_u24 v72, v83, s89, v82
    v_add_u32 v81, 39, v81
    s_waitcnt lgkmcnt(5)
    v_mfma_f32_32x32x16_bf16 v[240:255], v[208:211], v[84:87], v[240:255]
    v_mad_u32_u24 v74, v81, s89, v82
    s_lshl_b32 s88, s27, 8
    s_add_u32 s68, s20, s88
    s_addc_u32 s69, s21, 0
    s_waitcnt lgkmcnt(3)
    v_mfma_f32_32x32x16_bf16 v[240:255], v[212:215], v[88:91], v[240:255]
    s_and_b32 s69, s69, 0xffff
    s_lshl_b32 s70, s28, 8
    s_mov_b32 s86, 0xbf317218
    s_mov_b32 s87, 0xbf317218
    s_waitcnt lgkmcnt(1)
    v_mfma_f32_32x32x16_bf16 v[240:255], v[216:219], v[92:95], v[240:255]
    s_movk_i32 s89, 0x2000
    s_waitcnt lgkmcnt(0)
    v_mfma_f32_32x32x16_bf16 v[240:255], v[220:223], v[96:99], v[240:255]
    s_nop 11
    v_pk_fma_f32 v[240:241], v[240:241], s[86:87], v[224:225]
    v_pk_fma_f32 v[242:243], v[242:243], s[86:87], v[226:227]
    v_cvt_pk_bf16_f32 v36, v240, v241
    v_cvt_pk_bf16_f32 v37, v242, v243
    ds_write_b64 v71, v[36:37] offset:0
    v_pk_fma_f32 v[244:245], v[244:245], s[86:87], v[228:229]
    v_pk_fma_f32 v[246:247], v[246:247], s[86:87], v[230:231]
    v_cvt_pk_bf16_f32 v38, v244, v245
    v_cvt_pk_bf16_f32 v39, v246, v247
    ds_write_b64 v71, v[38:39] offset:16
    v_pk_fma_f32 v[248:249], v[248:249], s[86:87], v[232:233]
    v_pk_fma_f32 v[250:251], v[250:251], s[86:87], v[234:235]
    v_cvt_pk_bf16_f32 v40, v248, v249
    v_cvt_pk_bf16_f32 v41, v250, v251
    ds_write_b64 v71, v[40:41] offset:32
    v_pk_fma_f32 v[252:253], v[252:253], s[86:87], v[236:237]
    v_pk_fma_f32 v[254:255], v[254:255], s[86:87], v[238:239]
    v_cvt_pk_bf16_f32 v42, v252, v253
    v_cvt_pk_bf16_f32 v43, v254, v255
    ds_write_b64 v71, v[42:43] offset:48
    s_waitcnt lgkmcnt(0)
    s_barrier
    ds_read_b128 v[4:7], v72
    ds_read_b128 v[8:11], v74
    s_waitcnt lgkmcnt(1)
    buffer_store_dwordx4 v[4:7], v73, s[68:71], 0 offen sc1 nt
    s_cmp_ge_u32 s24, 5
    s_cbranch_scc1 K_FIN
    s_waitcnt lgkmcnt(0)
    buffer_store_dwordx4 v[8:11], v73, s[68:71], s89 offen sc1 nt
K_FIN:
    s_endpgm
K_W2A_O:
    s_mov_b32 s36, s16
    s_and_b32 s37, s17, 0xffff
    s_mov_b32 s38, 65536
    s_mov_b32 s39, 0x20000
    v_lshlrev_b32 v70, 4, v1
    s_lshl_b32 s89, s24, 11
    s_add_u32 m0, s89, 16928
    s_lshl_b32 s90, s88, 14
    s_add_u32 s89, s89, s90
    buffer_load_dwordx4 v70, s[36:39], s89 offen lds
    buffer_load_dwordx4 v70, s[36:39], s89 offen offset:1024 lds
    s_branch K_W2A
K_W2R_O:
    v_lshrrev_b32 v74, 5, v1
    v_bfe_u32 v75, v1, 2, 2
    v_lshl_add_u32 v74, v74, 4, v75
    v_bfe_u32 v75, v1, 4, 1
    v_and_b32 v76, 3, v1
    v_lshlrev_b32 v76, 3, v76
    v_lshl_add_u32 v75, v75, 5, v76
    v_lshl_add_u32 v74, v74, 8, v75
    s_and_b32 s89, s24, 1
    s_lshl_b32 s90, s89, 13
    s_lshr_b32 s91, s24, 1
    s_lshl_b32 s92, s91, 6
    s_add_u32 s90, s90, s92
    s_add_u32 s90, s90, 16928
    v_add_u32 v74, s90, v74
    s_lshr_b32 s90, s91, 1
    s_lshl_b32 s90, s90, 15
    s_and_b32 s92, s88, 1
    s_lshl_b32 s92, s92, 14
    s_add_u32 s90, s90, s92
    s_lshl_b32 s92, s89, 13
    s_add_u32 s90, s90, s92
    s_and_b32 s92, s91, 1
    s_lshl_b32 s92, s92, 8
    s_add_u32 s90, s90, s92
    s_lshr_b32 s92, s88, 1
    s_lshl_b32 s92, s92, 7
    s_add_u32 s90, s90, s92
    s_add_u32 s90, s90, 6406144
    v_lshrrev_b32 v75, 3, v1
    v_and_b32 v76, 7, v1
    v_lshlrev_b32 v76, 4, v76
    v_lshl_add_u32 v96, v75, 9, v76
    ds_read_b64_tr_b16 v[84:85], v74 offset:0
    ds_read_b64_tr_b16 v[86:87], v74 offset:2048
    ds_read_b64_tr_b16 v[88:89], v74 offset:1024
    ds_read_b64_tr_b16 v[90:91], v74 offset:3072
    s_mov_b32 s95, s90
    s_waitcnt lgkmcnt(0)
    s_branch K_W2R
K_W2DX_O:
    s_cmp_lt_u32 s88, 4
    s_cbranch_scc1 K_W2P
    v_mov_b32 v74, 0
    v_mov_b32 v75, 0
    v_lshlrev_b32 v76, 3, v1
    s_add_u32 s89, s47, 6404096
    buffer_store_dwordx2 v[74:75], v76, s[32:35], s89 offen sc1
    s_branch K_W2DX
K_W2P:
    s_add_u32 s90, s95, s47
    s_add_u32 s91, s90, 4096
    buffer_store_dwordx4 v[84:87], v96, s[32:35], s90 offen sc1
    buffer_store_dwordx4 v[88:91], v96, s[32:35], s91 offen sc1
    s_branch K_W2DX
K_END:
    s_endpgm
.section .rodata,"a"
.p2align 6
.amdhsa_kernel standalone__edge_featured_mpnn_mpnn__graph_kernel
  .amdhsa_next_free_vgpr 256
  .amdhsa_next_free_sgpr 102
  .amdhsa_accum_offset 256
  .amdhsa_group_segment_fixed_size 0
  .amdhsa_kernarg_size 88
  .amdhsa_user_sgpr_count 2
  .amdhsa_user_sgpr_kernarg_segment_ptr 1
  .amdhsa_system_sgpr_workgroup_id_x 1
.end_amdhsa_kernel
```
